```python
import torch

def _softmax(x, axis=-1):
    return torch.softmax(x, dim=axis)
def _gelu(x):
    return torch.nn.functional.gelu(x, approximate="tanh")
def _silu(x):
    return torch.nn.functional.silu(x)
def _sigmoid(x):
    return torch.sigmoid(x)
def _layernorm(x, axis=-1, eps=1e-5):
    m = x.mean(dim=axis, keepdim=True)
    v = x.var(dim=axis, keepdim=True, unbiased=False)
    return (x - m) / torch.sqrt(v + eps)
def _scatter_add(tgt, idx, src, axis=0):
    return tgt.clone().index_add_(axis, idx, src)
def _segment_sum(src, seg, n):
    out = torch.zeros((n,) + src.shape[1:], dtype=src.dtype)
    return out.index_add_(0, seg, src)
def _pad(x, pw):
    flat = tuple(v for pair in reversed(pw) for v in pair)
    return torch.nn.functional.pad(x, flat)

kernel_name = 'standalone__mha_block_cached__near_ridge'

def setup_inputs():

    _w = (lambda a: (lambda t: t.to(torch.bfloat16) if t.is_floating_point() else t)(torch.as_tensor(a)))
    B, Sq, D = 16, 128, 640
    H, Sk, Dh = 32, 1024, 128
    return {
        "x": _w((lambda *s: torch.randn(*s, dtype=torch.bfloat16) * 0.8)(B, Sq, D)),
        "k_cache": _w((lambda *s: torch.randn(*s, dtype=torch.bfloat16) * 0.8)(B, H, Sk, Dh)),
        "v_cache": _w((lambda *s: torch.randn(*s, dtype=torch.bfloat16) * 0.05)(B, H, Sk, Dh)),
        "wq": _w((lambda *s: torch.randn(*s, dtype=torch.bfloat16) * 0.8)(D, H * Dh) * (D ** -0.5)),
        "wo": _w((lambda *s: torch.randn(*s, dtype=torch.bfloat16) * 0.05)(H * Dh, D) * ((H * Dh) ** -0.5)),
    }

def reference(x, k_cache, v_cache, wq, wo):
    B, Sq, D = x.shape
    H, Dh = 32, 128
    q = (lambda x, *d: x.permute(*d))((x @ wq).reshape(B, Sq, H, Dh), 0, 2, 1, 3)
    scores = torch.einsum("bhqd,bhkd->bhqk", q, k_cache) * (Dh ** -0.5)
    p = _softmax(scores, axis=-1)
    o = torch.einsum("bhqk,bhkd->bhqd", p, v_cache)
    return (lambda x, *d: x.permute(*d))(o, 0, 2, 1, 3).reshape(B, Sq, H * Dh) @ wo
```

```asm
; @launch grid=(256,1,1) block=(512,1,1) lds=163840
.amdgcn_target "amdgcn-amd-amdhsa--gfx950"
.text
.globl standalone__mha_block_cached__near_ridge_kernel
.p2align 8
.type standalone__mha_block_cached__near_ridge_kernel,@function
standalone__mha_block_cached__near_ridge_kernel:
    s_cmp_ge_u32 s2, 256
    s_cbranch_scc1 standalone__mha_block_cached__near_ridge_kernel_done
    s_load_dwordx8 s[36:43], s[0:1], 0
    s_load_dwordx2 s[44:45], s[0:1], 56
    s_load_dwordx2 s[52:53], s[0:1], 32
    s_load_dwordx4 s[56:59], s[0:1], 40
    v_lshrrev_b32 v1, 6, v0
    v_and_b32 v0, 63, v0
    v_readfirstlane_b32 s3, v1
    s_and_b32 s4, s2, 7
    s_lshr_b32 s5, s2, 3
    s_lshr_b32 s6, s4, 1
    s_lshl_b32 s6, s6, 2
    s_and_b32 s7, s5, 3
    s_add_u32 s6, s6, s7
    s_and_b32 s7, s4, 1
    s_lshl_b32 s7, s7, 3
    s_lshr_b32 s5, s5, 2
    s_add_u32 s7, s7, s5
    s_waitcnt lgkmcnt(0)
    s_cmp_lt_u32 s3, 4
    s_cbranch_scc1 standalone__mha_block_cached__near_ridge_kernel_A
    s_sub_u32 s3, s3, 4
    s_mov_b32 s16, s42
    s_and_b32 s17, s43, 0xffff
    s_mov_b32 s18, 0x500000
    s_mov_b32 s19, 0x20000
    s_mov_b32 s20, s36
    s_and_b32 s21, s37, 0xffff
    s_mov_b32 s22, 0x280000
    s_mov_b32 s23, 0x20000
    v_lshrrev_b32 v4, 4, v0
    v_and_b32 v5, 15, v0
    v_lshlrev_b32 v6, 2, v4
    v_xor_b32 v6, v6, v5
    v_lshlrev_b32 v6, 4, v6
    v_lshl_add_u32 v240, v4, 13, v6
    v_lshl_add_u32 v249, v4, 8, v6
    v_lshrrev_b32 v6, 3, v0
    v_mul_u32_u24 v6, 1280, v6
    v_and_b32 v7, 7, v0
    v_add_u32 v8, 0, v4
    v_xor_b32 v8, v8, v7
    v_lshl_add_u32 v250, v8, 4, v6
    v_add_u32 v8, 4, v4
    v_xor_b32 v8, v8, v7
    v_lshl_add_u32 v251, v8, 4, v6
    s_lshl_b32 s28, s3, 17
    s_lshl_b32 s33, s6, 8
    s_add_u32 s28, s28, s33
    s_add_u32 s28, s28, 4096
    s_mul_i32 s29, s7, 163840
    s_mul_i32 s33, s3, 40960
    s_add_u32 s29, s29, s33
    s_lshl_b32 s30, s3, 12
    s_add_u32 m0, s30, 32768
    s_add_u32 s33, s29, 0
    buffer_load_dwordx4 v250, s[20:23], s33 offen lds
    s_add_u32 m0, s30, 33792
    s_add_u32 s33, s29, 10240
    buffer_load_dwordx4 v251, s[20:23], s33 offen lds
    s_add_u32 m0, s30, 34816
    s_add_u32 s33, s29, 20480
    buffer_load_dwordx4 v250, s[20:23], s33 offen lds
    s_add_u32 m0, s30, 35840
    s_add_u32 s33, s29, 30720
    buffer_load_dwordx4 v251, s[20:23], s33 offen lds
    s_add_u32 m0, s30, 16384
    s_add_u32 s33, s28, 0
    buffer_load_dwordx4 v240, s[16:19], s33 offen lds
    s_add_u32 m0, s30, 17408
    s_add_u32 s33, s28, 32768
    buffer_load_dwordx4 v240, s[16:19], s33 offen lds
    s_add_u32 m0, s30, 18432
    s_add_u32 s33, s28, 65536
    buffer_load_dwordx4 v240, s[16:19], s33 offen lds
    s_add_u32 m0, s30, 19456
    s_add_u32 s33, s28, 98304
    buffer_load_dwordx4 v240, s[16:19], s33 offen lds
    v_lshrrev_b32 v6, 5, v0
    v_bfe_u32 v8, v0, 2, 2
    v_lshl_add_u32 v9, v6, 3, v8
    v_lshlrev_b32 v9, 8, v9
    v_bfe_u32 v10, v0, 4, 1
    v_lshl_add_u32 v9, v10, 5, v9
    v_and_b32 v10, 1, v0
    v_lshl_add_u32 v9, v10, 4, v9
    v_bfe_u32 v10, v0, 1, 1
    v_lshl_add_u32 v9, v10, 3, v9
    v_add_u32 v9, 16384, v9
    v_xor_b32 v10, 0, v8
    v_lshl_add_u32 v96, v10, 6, v9
    v_add_u32 v100, 49152, v96
    v_add_u32 v104, 98304, v96
    v_xor_b32 v10, 1, v8
    v_lshl_add_u32 v97, v10, 6, v9
    v_add_u32 v101, 49152, v97
    v_add_u32 v105, 98304, v97
    v_xor_b32 v10, 2, v8
    v_lshl_add_u32 v98, v10, 6, v9
    v_add_u32 v102, 49152, v98
    v_add_u32 v106, 98304, v98
    v_xor_b32 v10, 3, v8
    v_lshl_add_u32 v99, v10, 6, v9
    v_add_u32 v103, 49152, v99
    v_add_u32 v107, 98304, v99
    v_and_b32 v8, 31, v0
    v_bfe_u32 v9, v0, 1, 3
    v_xor_b32 v9, v9, v6
    v_lshlrev_b32 v9, 4, v9
    v_lshl_add_u32 v9, v8, 7, v9
    s_add_u32 s33, s30, 32768
    v_add_u32 v9, s33, v9
    v_xor_b32 v108, 0, v9
    v_add_u32 v112, 49152, v108
    v_add_u32 v116, 98304, v108
    v_xor_b32 v109, 32, v9
    v_add_u32 v113, 49152, v109
    v_add_u32 v117, 98304, v109
    v_xor_b32 v110, 64, v9
    v_add_u32 v114, 49152, v110
    v_add_u32 v118, 98304, v110
    v_xor_b32 v111, 96, v9
    v_add_u32 v115, 49152, v111
    v_add_u32 v119, 98304, v111
    s_add_u32 m0, s30, 81920
    s_add_u32 s33, s29, 128
    buffer_load_dwordx4 v250, s[20:23], s33 offen lds
    s_add_u32 m0, s30, 82944
    s_add_u32 s33, s29, 10368
    buffer_load_dwordx4 v251, s[20:23], s33 offen lds
    s_add_u32 m0, s30, 83968
    s_add_u32 s33, s29, 20608
    buffer_load_dwordx4 v250, s[20:23], s33 offen lds
    s_add_u32 m0, s30, 84992
    s_add_u32 s33, s29, 30848
    buffer_load_dwordx4 v251, s[20:23], s33 offen lds
    s_add_u32 m0, s30, 65536
    s_add_u32 s33, s28, 524288
    buffer_load_dwordx4 v240, s[16:19], s33 offen lds
    s_add_u32 m0, s30, 66560
    s_add_u32 s33, s28, 557056
    buffer_load_dwordx4 v240, s[16:19], s33 offen lds
    s_add_u32 m0, s30, 67584
    s_add_u32 s33, s28, 589824
    buffer_load_dwordx4 v240, s[16:19], s33 offen lds
    s_add_u32 m0, s30, 68608
    s_add_u32 s33, s28, 622592
    buffer_load_dwordx4 v240, s[16:19], s33 offen lds
    s_add_u32 m0, s30, 131072
    s_add_u32 s33, s29, 256
    buffer_load_dwordx4 v250, s[20:23], s33 offen lds
    s_add_u32 m0, s30, 132096
    s_add_u32 s33, s29, 10496
    buffer_load_dwordx4 v251, s[20:23], s33 offen lds
    s_add_u32 m0, s30, 133120
    s_add_u32 s33, s29, 20736
    buffer_load_dwordx4 v250, s[20:23], s33 offen lds
    s_add_u32 m0, s30, 134144
    s_add_u32 s33, s29, 30976
    buffer_load_dwordx4 v251, s[20:23], s33 offen lds
    s_add_u32 m0, s30, 114688
    s_add_u32 s33, s28, 1048576
    buffer_load_dwordx4 v240, s[16:19], s33 offen lds
    s_add_u32 m0, s30, 115712
    s_add_u32 s33, s28, 1081344
    buffer_load_dwordx4 v240, s[16:19], s33 offen lds
    s_add_u32 m0, s30, 116736
    s_add_u32 s33, s28, 1114112
    buffer_load_dwordx4 v240, s[16:19], s33 offen lds
    s_add_u32 m0, s30, 117760
    s_add_u32 s33, s28, 1146880
    buffer_load_dwordx4 v240, s[16:19], s33 offen lds
    s_mov_b32 s48, 0x3e0293ee
    s_mov_b32 s8, s38
    s_and_b32 s9, s39, 0xffff
    s_mov_b32 s10, 0x8000000
    s_mov_b32 s11, 0x20000
    s_mov_b32 s12, s40
    s_and_b32 s13, s41, 0xffff
    s_mov_b32 s14, 0x8000000
    s_mov_b32 s15, 0x20000
    s_mov_b32 s24, s44
    s_and_b32 s25, s45, 0xffff
    s_mov_b32 s26, 0x2000000
    s_mov_b32 s27, 0x20000
    v_add_u32 v6, 0, v4
    v_xor_b32 v6, v6, v5
    v_lshlrev_b32 v6, 4, v6
    v_lshl_add_u32 v245, v4, 8, v6
    v_add_u32 v6, 4, v4
    v_xor_b32 v6, v6, v5
    v_lshlrev_b32 v6, 4, v6
    v_lshl_add_u32 v246, v4, 8, v6
    v_add_u32 v6, 8, v4
    v_xor_b32 v6, v6, v5
    v_lshlrev_b32 v6, 4, v6
    v_lshl_add_u32 v247, v4, 8, v6
    v_add_u32 v6, 12, v4
    v_xor_b32 v6, v6, v5
    v_lshlrev_b32 v6, 4, v6
    v_lshl_add_u32 v248, v4, 8, v6
    s_lshl_b32 s31, s7, 5
    s_add_u32 s31, s31, s6
    s_lshl_b32 s31, s31, 18
    s_add_u32 s31, s31, s30
    s_add_u32 s32, s30, 65536
    s_mov_b32 s34, 0
    s_waitcnt vmcnt(16)
    s_barrier
    ds_read_b128 v[160:163], v108
    ds_read_b64_tr_b16 v[192:193], v96
    ds_read_b64_tr_b16 v[194:195], v96 offset:1024
    ds_read_b64_tr_b16 v[196:197], v97
    ds_read_b64_tr_b16 v[198:199], v97 offset:1024
    ds_read_b64_tr_b16 v[200:201], v98
    ds_read_b64_tr_b16 v[202:203], v98 offset:1024
    ds_read_b64_tr_b16 v[204:205], v99
    ds_read_b64_tr_b16 v[206:207], v99 offset:1024
    ds_read_b128 v[164:167], v109
    ds_read_b128 v[168:171], v110
    ds_read_b128 v[172:175], v111
    s_waitcnt lgkmcnt(3)
    ds_read_b64_tr_b16 v[208:209], v96 offset:4096
    ds_read_b64_tr_b16 v[210:211], v96 offset:5120
    ds_read_b64_tr_b16 v[212:213], v97 offset:4096
    ds_read_b64_tr_b16 v[214:215], v97 offset:5120
    ds_read_b64_tr_b16 v[216:217], v98 offset:4096
    ds_read_b64_tr_b16 v[218:219], v98 offset:5120
    ds_read_b64_tr_b16 v[220:221], v99 offset:4096
    ds_read_b64_tr_b16 v[222:223], v99 offset:5120
    v_mfma_f32_32x32x16_bf16 v[0:15], v[192:195], v[160:163], 0
    v_mfma_f32_32x32x16_bf16 v[16:31], v[196:199], v[160:163], 0
    v_mfma_f32_32x32x16_bf16 v[32:47], v[200:203], v[160:163], 0
    v_mfma_f32_32x32x16_bf16 v[48:63], v[204:207], v[160:163], 0
    ds_read_b64_tr_b16 v[192:193], v96 offset:8192
    ds_read_b64_tr_b16 v[194:195], v96 offset:9216
    ds_read_b64_tr_b16 v[196:197], v97 offset:8192
    ds_read_b64_tr_b16 v[198:199], v97 offset:9216
    s_waitcnt lgkmcnt(14)
    ds_read_b64_tr_b16 v[200:201], v98 offset:8192
    s_waitcnt lgkmcnt(14)
    ds_read_b64_tr_b16 v[202:203], v98 offset:9216
    s_waitcnt lgkmcnt(14)
    ds_read_b64_tr_b16 v[204:205], v99 offset:8192
    s_waitcnt lgkmcnt(14)
    ds_read_b64_tr_b16 v[206:207], v99 offset:9216
    s_waitcnt lgkmcnt(8)
    v_mfma_f32_32x32x16_bf16 v[0:15], v[208:211], v[164:167], v[0:15]
    v_mfma_f32_32x32x16_bf16 v[16:31], v[212:215], v[164:167], v[16:31]
    v_mfma_f32_32x32x16_bf16 v[32:47], v[216:219], v[164:167], v[32:47]
    v_mfma_f32_32x32x16_bf16 v[48:63], v[220:223], v[164:167], v[48:63]
    ds_read_b64_tr_b16 v[208:209], v96 offset:12288
    ds_read_b64_tr_b16 v[210:211], v96 offset:13312
    ds_read_b64_tr_b16 v[212:213], v97 offset:12288
    ds_read_b64_tr_b16 v[214:215], v97 offset:13312
    ds_read_b64_tr_b16 v[216:217], v98 offset:12288
    ds_read_b64_tr_b16 v[218:219], v98 offset:13312
    ds_read_b64_tr_b16 v[220:221], v99 offset:12288
    s_waitcnt lgkmcnt(14)
    ds_read_b64_tr_b16 v[222:223], v99 offset:13312
    s_waitcnt lgkmcnt(8)
    v_mfma_f32_32x32x16_bf16 v[0:15], v[192:195], v[168:171], v[0:15]
    v_mfma_f32_32x32x16_bf16 v[16:31], v[196:199], v[168:171], v[16:31]
    v_mfma_f32_32x32x16_bf16 v[32:47], v[200:203], v[168:171], v[32:47]
    v_mfma_f32_32x32x16_bf16 v[48:63], v[204:207], v[168:171], v[48:63]
    s_waitcnt lgkmcnt(0)
    s_waitcnt vmcnt(8)
    s_barrier
    ds_read_b128 v[160:163], v112
    ds_read_b64_tr_b16 v[192:193], v100
    ds_read_b64_tr_b16 v[194:195], v100 offset:1024
    ds_read_b64_tr_b16 v[196:197], v101
    ds_read_b64_tr_b16 v[198:199], v101 offset:1024
    ds_read_b64_tr_b16 v[200:201], v102
    ds_read_b64_tr_b16 v[202:203], v102 offset:1024
    ds_read_b64_tr_b16 v[204:205], v103
    ds_read_b64_tr_b16 v[206:207], v103 offset:1024
    v_mfma_f32_32x32x16_bf16 v[0:15], v[208:211], v[172:175], v[0:15]
    s_add_u32 m0, s30, 32768
    s_add_u32 s33, s29, 384
    buffer_load_dwordx4 v250, s[20:23], s33 offen lds
    v_mfma_f32_32x32x16_bf16 v[16:31], v[212:215], v[172:175], v[16:31]
    v_mfma_f32_32x32x16_bf16 v[32:47], v[216:219], v[172:175], v[32:47]
    s_add_u32 m0, s30, 33792
    s_add_u32 s33, s29, 10624
    buffer_load_dwordx4 v251, s[20:23], s33 offen lds
    v_mfma_f32_32x32x16_bf16 v[48:63], v[220:223], v[172:175], v[48:63]
    ds_read_b128 v[164:167], v113
    ds_read_b128 v[168:171], v114
    ds_read_b128 v[172:175], v115
    s_waitcnt lgkmcnt(3)
    ds_read_b64_tr_b16 v[208:209], v100 offset:4096
    ds_read_b64_tr_b16 v[210:211], v100 offset:5120
    ds_read_b64_tr_b16 v[212:213], v101 offset:4096
    ds_read_b64_tr_b16 v[214:215], v101 offset:5120
    ds_read_b64_tr_b16 v[216:217], v102 offset:4096
    ds_read_b64_tr_b16 v[218:219], v102 offset:5120
    ds_read_b64_tr_b16 v[220:221], v103 offset:4096
    ds_read_b64_tr_b16 v[222:223], v103 offset:5120
    v_mfma_f32_32x32x16_bf16 v[0:15], v[192:195], v[160:163], v[0:15]
    s_add_u32 m0, s30, 34816
    s_add_u32 s33, s29, 20864
    buffer_load_dwordx4 v250, s[20:23], s33 offen lds
    v_mfma_f32_32x32x16_bf16 v[16:31], v[196:199], v[160:163], v[16:31]
    v_mfma_f32_32x32x16_bf16 v[32:47], v[200:203], v[160:163], v[32:47]
    s_add_u32 m0, s30, 35840
    s_add_u32 s33, s29, 31104
    buffer_load_dwordx4 v251, s[20:23], s33 offen lds
    v_mfma_f32_32x32x16_bf16 v[48:63], v[204:207], v[160:163], v[48:63]
    ds_read_b64_tr_b16 v[192:193], v100 offset:8192
    ds_read_b64_tr_b16 v[194:195], v100 offset:9216
    ds_read_b64_tr_b16 v[196:197], v101 offset:8192
    ds_read_b64_tr_b16 v[198:199], v101 offset:9216
    s_waitcnt lgkmcnt(14)
    ds_read_b64_tr_b16 v[200:201], v102 offset:8192
    s_waitcnt lgkmcnt(14)
    ds_read_b64_tr_b16 v[202:203], v102 offset:9216
    s_waitcnt lgkmcnt(14)
    ds_read_b64_tr_b16 v[204:205], v103 offset:8192
    s_waitcnt lgkmcnt(14)
    ds_read_b64_tr_b16 v[206:207], v103 offset:9216
    s_waitcnt lgkmcnt(8)
    v_mfma_f32_32x32x16_bf16 v[0:15], v[208:211], v[164:167], v[0:15]
    s_add_u32 m0, s30, 16384
    s_add_u32 s33, s28, 1572864
    buffer_load_dwordx4 v240, s[16:19], s33 offen lds
    v_mfma_f32_32x32x16_bf16 v[16:31], v[212:215], v[164:167], v[16:31]
    v_mfma_f32_32x32x16_bf16 v[32:47], v[216:219], v[164:167], v[32:47]
    s_add_u32 m0, s30, 17408
    s_add_u32 s33, s28, 1605632
    buffer_load_dwordx4 v240, s[16:19], s33 offen lds
    v_mfma_f32_32x32x16_bf16 v[48:63], v[220:223], v[164:167], v[48:63]
    ds_read_b64_tr_b16 v[208:209], v100 offset:12288
    ds_read_b64_tr_b16 v[210:211], v100 offset:13312
    ds_read_b64_tr_b16 v[212:213], v101 offset:12288
    ds_read_b64_tr_b16 v[214:215], v101 offset:13312
    ds_read_b64_tr_b16 v[216:217], v102 offset:12288
    ds_read_b64_tr_b16 v[218:219], v102 offset:13312
    ds_read_b64_tr_b16 v[220:221], v103 offset:12288
    s_waitcnt lgkmcnt(14)
    ds_read_b64_tr_b16 v[222:223], v103 offset:13312
    s_waitcnt lgkmcnt(8)
    v_mfma_f32_32x32x16_bf16 v[0:15], v[192:195], v[168:171], v[0:15]
    s_add_u32 m0, s30, 18432
    s_add_u32 s33, s28, 1638400
    buffer_load_dwordx4 v240, s[16:19], s33 offen lds
    v_mfma_f32_32x32x16_bf16 v[16:31], v[196:199], v[168:171], v[16:31]
    v_mfma_f32_32x32x16_bf16 v[32:47], v[200:203], v[168:171], v[32:47]
    s_add_u32 m0, s30, 19456
    s_add_u32 s33, s28, 1671168
    buffer_load_dwordx4 v240, s[16:19], s33 offen lds
    v_mfma_f32_32x32x16_bf16 v[48:63], v[204:207], v[168:171], v[48:63]
    s_waitcnt lgkmcnt(0)
    s_waitcnt vmcnt(8)
    s_barrier
    ds_read_b128 v[160:163], v116
    ds_read_b64_tr_b16 v[192:193], v104
    ds_read_b64_tr_b16 v[194:195], v104 offset:1024
    ds_read_b64_tr_b16 v[196:197], v105
    ds_read_b64_tr_b16 v[198:199], v105 offset:1024
    ds_read_b64_tr_b16 v[200:201], v106
    ds_read_b64_tr_b16 v[202:203], v106 offset:1024
    ds_read_b64_tr_b16 v[204:205], v107
    ds_read_b64_tr_b16 v[206:207], v107 offset:1024
    v_mfma_f32_32x32x16_bf16 v[0:15], v[208:211], v[172:175], v[0:15]
    s_add_u32 m0, s30, 81920
    s_add_u32 s33, s29, 512
    buffer_load_dwordx4 v250, s[20:23], s33 offen lds
    v_mfma_f32_32x32x16_bf16 v[16:31], v[212:215], v[172:175], v[16:31]
    v_mfma_f32_32x32x16_bf16 v[32:47], v[216:219], v[172:175], v[32:47]
    s_add_u32 m0, s30, 82944
    s_add_u32 s33, s29, 10752
    buffer_load_dwordx4 v251, s[20:23], s33 offen lds
    v_mfma_f32_32x32x16_bf16 v[48:63], v[220:223], v[172:175], v[48:63]
    ds_read_b128 v[164:167], v117
    ds_read_b128 v[168:171], v118
    ds_read_b128 v[172:175], v119
    s_waitcnt lgkmcnt(3)
    ds_read_b64_tr_b16 v[208:209], v104 offset:4096
    ds_read_b64_tr_b16 v[210:211], v104 offset:5120
    ds_read_b64_tr_b16 v[212:213], v105 offset:4096
    ds_read_b64_tr_b16 v[214:215], v105 offset:5120
    ds_read_b64_tr_b16 v[216:217], v106 offset:4096
    ds_read_b64_tr_b16 v[218:219], v106 offset:5120
    ds_read_b64_tr_b16 v[220:221], v107 offset:4096
    ds_read_b64_tr_b16 v[222:223], v107 offset:5120
    v_mfma_f32_32x32x16_bf16 v[0:15], v[192:195], v[160:163], v[0:15]
    s_add_u32 m0, s30, 83968
    s_add_u32 s33, s29, 20992
    buffer_load_dwordx4 v250, s[20:23], s33 offen lds
    v_mfma_f32_32x32x16_bf16 v[16:31], v[196:199], v[160:163], v[16:31]
    v_mfma_f32_32x32x16_bf16 v[32:47], v[200:203], v[160:163], v[32:47]
    s_add_u32 m0, s30, 84992
    s_add_u32 s33, s29, 31232
    buffer_load_dwordx4 v251, s[20:23], s33 offen lds
    v_mfma_f32_32x32x16_bf16 v[48:63], v[204:207], v[160:163], v[48:63]
    ds_read_b64_tr_b16 v[192:193], v104 offset:8192
    ds_read_b64_tr_b16 v[194:195], v104 offset:9216
    ds_read_b64_tr_b16 v[196:197], v105 offset:8192
    ds_read_b64_tr_b16 v[198:199], v105 offset:9216
    s_waitcnt lgkmcnt(14)
    ds_read_b64_tr_b16 v[200:201], v106 offset:8192
    s_waitcnt lgkmcnt(14)
    ds_read_b64_tr_b16 v[202:203], v106 offset:9216
    s_waitcnt lgkmcnt(14)
    ds_read_b64_tr_b16 v[204:205], v107 offset:8192
    s_waitcnt lgkmcnt(14)
    ds_read_b64_tr_b16 v[206:207], v107 offset:9216
    s_waitcnt lgkmcnt(8)
    v_mfma_f32_32x32x16_bf16 v[0:15], v[208:211], v[164:167], v[0:15]
    s_add_u32 m0, s30, 65536
    s_add_u32 s33, s28, 2097152
    buffer_load_dwordx4 v240, s[16:19], s33 offen lds
    v_mfma_f32_32x32x16_bf16 v[16:31], v[212:215], v[164:167], v[16:31]
    v_mfma_f32_32x32x16_bf16 v[32:47], v[216:219], v[164:167], v[32:47]
    s_add_u32 m0, s30, 66560
    s_add_u32 s33, s28, 2129920
    buffer_load_dwordx4 v240, s[16:19], s33 offen lds
    v_mfma_f32_32x32x16_bf16 v[48:63], v[220:223], v[164:167], v[48:63]
    ds_read_b64_tr_b16 v[208:209], v104 offset:12288
    ds_read_b64_tr_b16 v[210:211], v104 offset:13312
    ds_read_b64_tr_b16 v[212:213], v105 offset:12288
    ds_read_b64_tr_b16 v[214:215], v105 offset:13312
    ds_read_b64_tr_b16 v[216:217], v106 offset:12288
    ds_read_b64_tr_b16 v[218:219], v106 offset:13312
    ds_read_b64_tr_b16 v[220:221], v107 offset:12288
    s_waitcnt lgkmcnt(14)
    ds_read_b64_tr_b16 v[222:223], v107 offset:13312
    s_waitcnt lgkmcnt(8)
    v_mfma_f32_32x32x16_bf16 v[0:15], v[192:195], v[168:171], v[0:15]
    s_add_u32 m0, s30, 67584
    s_add_u32 s33, s28, 2162688
    buffer_load_dwordx4 v240, s[16:19], s33 offen lds
    v_mfma_f32_32x32x16_bf16 v[16:31], v[196:199], v[168:171], v[16:31]
    v_mfma_f32_32x32x16_bf16 v[32:47], v[200:203], v[168:171], v[32:47]
    s_add_u32 m0, s30, 68608
    s_add_u32 s33, s28, 2195456
    buffer_load_dwordx4 v240, s[16:19], s33 offen lds
    v_mfma_f32_32x32x16_bf16 v[48:63], v[204:207], v[168:171], v[48:63]
    s_waitcnt lgkmcnt(0)
    s_waitcnt vmcnt(8)
    s_barrier
    ds_read_b128 v[160:163], v108
    ds_read_b64_tr_b16 v[192:193], v96
    ds_read_b64_tr_b16 v[194:195], v96 offset:1024
    ds_read_b64_tr_b16 v[196:197], v97
    ds_read_b64_tr_b16 v[198:199], v97 offset:1024
    ds_read_b64_tr_b16 v[200:201], v98
    ds_read_b64_tr_b16 v[202:203], v98 offset:1024
    ds_read_b64_tr_b16 v[204:205], v99
    ds_read_b64_tr_b16 v[206:207], v99 offset:1024
    v_mfma_f32_32x32x16_bf16 v[0:15], v[208:211], v[172:175], v[0:15]
    s_add_u32 m0, s30, 131072
    s_add_u32 s33, s29, 640
    buffer_load_dwordx4 v250, s[20:23], s33 offen lds
    v_mfma_f32_32x32x16_bf16 v[16:31], v[212:215], v[172:175], v[16:31]
    v_mfma_f32_32x32x16_bf16 v[32:47], v[216:219], v[172:175], v[32:47]
    s_add_u32 m0, s30, 132096
    s_add_u32 s33, s29, 10880
    buffer_load_dwordx4 v251, s[20:23], s33 offen lds
    v_mfma_f32_32x32x16_bf16 v[48:63], v[220:223], v[172:175], v[48:63]
    ds_read_b128 v[164:167], v109
    ds_read_b128 v[168:171], v110
    ds_read_b128 v[172:175], v111
    s_waitcnt lgkmcnt(3)
    ds_read_b64_tr_b16 v[208:209], v96 offset:4096
    ds_read_b64_tr_b16 v[210:211], v96 offset:5120
    ds_read_b64_tr_b16 v[212:213], v97 offset:4096
    ds_read_b64_tr_b16 v[214:215], v97 offset:5120
    ds_read_b64_tr_b16 v[216:217], v98 offset:4096
    ds_read_b64_tr_b16 v[218:219], v98 offset:5120
    ds_read_b64_tr_b16 v[220:221], v99 offset:4096
    ds_read_b64_tr_b16 v[222:223], v99 offset:5120
    v_mfma_f32_32x32x16_bf16 v[0:15], v[192:195], v[160:163], v[0:15]
    s_add_u32 m0, s30, 133120
    s_add_u32 s33, s29, 21120
    buffer_load_dwordx4 v250, s[20:23], s33 offen lds
    v_mfma_f32_32x32x16_bf16 v[16:31], v[196:199], v[160:163], v[16:31]
    v_mfma_f32_32x32x16_bf16 v[32:47], v[200:203], v[160:163], v[32:47]
    s_add_u32 m0, s30, 134144
    s_add_u32 s33, s29, 31360
    buffer_load_dwordx4 v251, s[20:23], s33 offen lds
    v_mfma_f32_32x32x16_bf16 v[48:63], v[204:207], v[160:163], v[48:63]
    ds_read_b64_tr_b16 v[192:193], v96 offset:8192
    ds_read_b64_tr_b16 v[194:195], v96 offset:9216
    ds_read_b64_tr_b16 v[196:197], v97 offset:8192
    ds_read_b64_tr_b16 v[198:199], v97 offset:9216
    s_waitcnt lgkmcnt(14)
    ds_read_b64_tr_b16 v[200:201], v98 offset:8192
    s_waitcnt lgkmcnt(14)
    ds_read_b64_tr_b16 v[202:203], v98 offset:9216
    s_waitcnt lgkmcnt(14)
    ds_read_b64_tr_b16 v[204:205], v99 offset:8192
    s_waitcnt lgkmcnt(14)
    ds_read_b64_tr_b16 v[206:207], v99 offset:9216
    s_waitcnt lgkmcnt(8)
    v_mfma_f32_32x32x16_bf16 v[0:15], v[208:211], v[164:167], v[0:15]
    s_add_u32 m0, s30, 114688
    s_add_u32 s33, s28, 2621440
    buffer_load_dwordx4 v240, s[16:19], s33 offen lds
    v_mfma_f32_32x32x16_bf16 v[16:31], v[212:215], v[164:167], v[16:31]
    v_mfma_f32_32x32x16_bf16 v[32:47], v[216:219], v[164:167], v[32:47]
    s_add_u32 m0, s30, 115712
    s_add_u32 s33, s28, 2654208
    buffer_load_dwordx4 v240, s[16:19], s33 offen lds
    v_mfma_f32_32x32x16_bf16 v[48:63], v[220:223], v[164:167], v[48:63]
    ds_read_b64_tr_b16 v[208:209], v96 offset:12288
    ds_read_b64_tr_b16 v[210:211], v96 offset:13312
    ds_read_b64_tr_b16 v[212:213], v97 offset:12288
    ds_read_b64_tr_b16 v[214:215], v97 offset:13312
    ds_read_b64_tr_b16 v[216:217], v98 offset:12288
    ds_read_b64_tr_b16 v[218:219], v98 offset:13312
    ds_read_b64_tr_b16 v[220:221], v99 offset:12288
    s_waitcnt lgkmcnt(14)
    ds_read_b64_tr_b16 v[222:223], v99 offset:13312
    s_waitcnt lgkmcnt(8)
    v_mfma_f32_32x32x16_bf16 v[0:15], v[192:195], v[168:171], v[0:15]
    s_add_u32 m0, s30, 116736
    s_add_u32 s33, s28, 2686976
    buffer_load_dwordx4 v240, s[16:19], s33 offen lds
    v_mfma_f32_32x32x16_bf16 v[16:31], v[196:199], v[168:171], v[16:31]
    v_mfma_f32_32x32x16_bf16 v[32:47], v[200:203], v[168:171], v[32:47]
    s_add_u32 m0, s30, 117760
    s_add_u32 s33, s28, 2719744
    buffer_load_dwordx4 v240, s[16:19], s33 offen lds
    v_mfma_f32_32x32x16_bf16 v[48:63], v[204:207], v[168:171], v[48:63]
    s_waitcnt lgkmcnt(0)
    s_waitcnt vmcnt(8)
    s_barrier
    ds_read_b128 v[160:163], v112
    ds_read_b64_tr_b16 v[192:193], v100
    ds_read_b64_tr_b16 v[194:195], v100 offset:1024
    ds_read_b64_tr_b16 v[196:197], v101
    ds_read_b64_tr_b16 v[198:199], v101 offset:1024
    ds_read_b64_tr_b16 v[200:201], v102
    ds_read_b64_tr_b16 v[202:203], v102 offset:1024
    ds_read_b64_tr_b16 v[204:205], v103
    ds_read_b64_tr_b16 v[206:207], v103 offset:1024
    v_mfma_f32_32x32x16_bf16 v[0:15], v[208:211], v[172:175], v[0:15]
    s_add_u32 m0, s30, 32768
    s_add_u32 s33, s29, 768
    buffer_load_dwordx4 v250, s[20:23], s33 offen lds
    v_mfma_f32_32x32x16_bf16 v[16:31], v[212:215], v[172:175], v[16:31]
    v_mfma_f32_32x32x16_bf16 v[32:47], v[216:219], v[172:175], v[32:47]
    s_add_u32 m0, s30, 33792
    s_add_u32 s33, s29, 11008
    buffer_load_dwordx4 v251, s[20:23], s33 offen lds
    v_mfma_f32_32x32x16_bf16 v[48:63], v[220:223], v[172:175], v[48:63]
    ds_read_b128 v[164:167], v113
    ds_read_b128 v[168:171], v114
    ds_read_b128 v[172:175], v115
    s_waitcnt lgkmcnt(3)
    ds_read_b64_tr_b16 v[208:209], v100 offset:4096
    ds_read_b64_tr_b16 v[210:211], v100 offset:5120
    ds_read_b64_tr_b16 v[212:213], v101 offset:4096
    ds_read_b64_tr_b16 v[214:215], v101 offset:5120
    ds_read_b64_tr_b16 v[216:217], v102 offset:4096
    ds_read_b64_tr_b16 v[218:219], v102 offset:5120
    ds_read_b64_tr_b16 v[220:221], v103 offset:4096
    ds_read_b64_tr_b16 v[222:223], v103 offset:5120
    v_mfma_f32_32x32x16_bf16 v[0:15], v[192:195], v[160:163], v[0:15]
    s_add_u32 m0, s30, 34816
    s_add_u32 s33, s29, 21248
    buffer_load_dwordx4 v250, s[20:23], s33 offen lds
    v_mfma_f32_32x32x16_bf16 v[16:31], v[196:199], v[160:163], v[16:31]
    v_mfma_f32_32x32x16_bf16 v[32:47], v[200:203], v[160:163], v[32:47]
    s_add_u32 m0, s30, 35840
    s_add_u32 s33, s29, 31488
    buffer_load_dwordx4 v251, s[20:23], s33 offen lds
    v_mfma_f32_32x32x16_bf16 v[48:63], v[204:207], v[160:163], v[48:63]
    ds_read_b64_tr_b16 v[192:193], v100 offset:8192
    ds_read_b64_tr_b16 v[194:195], v100 offset:9216
    ds_read_b64_tr_b16 v[196:197], v101 offset:8192
    ds_read_b64_tr_b16 v[198:199], v101 offset:9216
    s_waitcnt lgkmcnt(14)
    ds_read_b64_tr_b16 v[200:201], v102 offset:8192
    s_waitcnt lgkmcnt(14)
    ds_read_b64_tr_b16 v[202:203], v102 offset:9216
    s_waitcnt lgkmcnt(14)
    ds_read_b64_tr_b16 v[204:205], v103 offset:8192
    s_waitcnt lgkmcnt(14)
    ds_read_b64_tr_b16 v[206:207], v103 offset:9216
    s_waitcnt lgkmcnt(8)
    v_mfma_f32_32x32x16_bf16 v[0:15], v[208:211], v[164:167], v[0:15]
    s_add_u32 m0, s30, 16384
    s_add_u32 s33, s28, 3145728
    buffer_load_dwordx4 v240, s[16:19], s33 offen lds
    v_mfma_f32_32x32x16_bf16 v[16:31], v[212:215], v[164:167], v[16:31]
    v_mfma_f32_32x32x16_bf16 v[32:47], v[216:219], v[164:167], v[32:47]
    s_add_u32 m0, s30, 17408
    s_add_u32 s33, s28, 3178496
    buffer_load_dwordx4 v240, s[16:19], s33 offen lds
    v_mfma_f32_32x32x16_bf16 v[48:63], v[220:223], v[164:167], v[48:63]
    ds_read_b64_tr_b16 v[208:209], v100 offset:12288
    ds_read_b64_tr_b16 v[210:211], v100 offset:13312
    ds_read_b64_tr_b16 v[212:213], v101 offset:12288
    ds_read_b64_tr_b16 v[214:215], v101 offset:13312
    ds_read_b64_tr_b16 v[216:217], v102 offset:12288
    ds_read_b64_tr_b16 v[218:219], v102 offset:13312
    ds_read_b64_tr_b16 v[220:221], v103 offset:12288
    s_waitcnt lgkmcnt(14)
    ds_read_b64_tr_b16 v[222:223], v103 offset:13312
    s_waitcnt lgkmcnt(8)
    v_mfma_f32_32x32x16_bf16 v[0:15], v[192:195], v[168:171], v[0:15]
    s_add_u32 m0, s30, 18432
    s_add_u32 s33, s28, 3211264
    buffer_load_dwordx4 v240, s[16:19], s33 offen lds
    v_mfma_f32_32x32x16_bf16 v[16:31], v[196:199], v[168:171], v[16:31]
    v_mfma_f32_32x32x16_bf16 v[32:47], v[200:203], v[168:171], v[32:47]
    s_add_u32 m0, s30, 19456
    s_add_u32 s33, s28, 3244032
    buffer_load_dwordx4 v240, s[16:19], s33 offen lds
    v_mfma_f32_32x32x16_bf16 v[48:63], v[204:207], v[168:171], v[48:63]
    s_waitcnt lgkmcnt(0)
    s_waitcnt vmcnt(8)
    s_barrier
    ds_read_b128 v[160:163], v116
    ds_read_b64_tr_b16 v[192:193], v104
    ds_read_b64_tr_b16 v[194:195], v104 offset:1024
    ds_read_b64_tr_b16 v[196:197], v105
    ds_read_b64_tr_b16 v[198:199], v105 offset:1024
    ds_read_b64_tr_b16 v[200:201], v106
    ds_read_b64_tr_b16 v[202:203], v106 offset:1024
    ds_read_b64_tr_b16 v[204:205], v107
    ds_read_b64_tr_b16 v[206:207], v107 offset:1024
    v_mfma_f32_32x32x16_bf16 v[0:15], v[208:211], v[172:175], v[0:15]
    s_add_u32 m0, s30, 81920
    s_add_u32 s33, s29, 896
    buffer_load_dwordx4 v250, s[20:23], s33 offen lds
    v_mfma_f32_32x32x16_bf16 v[16:31], v[212:215], v[172:175], v[16:31]
    v_mfma_f32_32x32x16_bf16 v[32:47], v[216:219], v[172:175], v[32:47]
    s_add_u32 m0, s30, 82944
    s_add_u32 s33, s29, 11136
    buffer_load_dwordx4 v251, s[20:23], s33 offen lds
    v_mfma_f32_32x32x16_bf16 v[48:63], v[220:223], v[172:175], v[48:63]
    ds_read_b128 v[164:167], v117
    ds_read_b128 v[168:171], v118
    ds_read_b128 v[172:175], v119
    s_waitcnt lgkmcnt(3)
    ds_read_b64_tr_b16 v[208:209], v104 offset:4096
    ds_read_b64_tr_b16 v[210:211], v104 offset:5120
    ds_read_b64_tr_b16 v[212:213], v105 offset:4096
    ds_read_b64_tr_b16 v[214:215], v105 offset:5120
    ds_read_b64_tr_b16 v[216:217], v106 offset:4096
    ds_read_b64_tr_b16 v[218:219], v106 offset:5120
    ds_read_b64_tr_b16 v[220:221], v107 offset:4096
    ds_read_b64_tr_b16 v[222:223], v107 offset:5120
    v_mfma_f32_32x32x16_bf16 v[0:15], v[192:195], v[160:163], v[0:15]
    s_add_u32 m0, s30, 83968
    s_add_u32 s33, s29, 21376
    buffer_load_dwordx4 v250, s[20:23], s33 offen lds
    v_mfma_f32_32x32x16_bf16 v[16:31], v[196:199], v[160:163], v[16:31]
    v_mfma_f32_32x32x16_bf16 v[32:47], v[200:203], v[160:163], v[32:47]
    s_add_u32 m0, s30, 84992
    s_add_u32 s33, s29, 31616
    buffer_load_dwordx4 v251, s[20:23], s33 offen lds
    v_mfma_f32_32x32x16_bf16 v[48:63], v[204:207], v[160:163], v[48:63]
    ds_read_b64_tr_b16 v[192:193], v104 offset:8192
    ds_read_b64_tr_b16 v[194:195], v104 offset:9216
    ds_read_b64_tr_b16 v[196:197], v105 offset:8192
    ds_read_b64_tr_b16 v[198:199], v105 offset:9216
    s_waitcnt lgkmcnt(14)
    ds_read_b64_tr_b16 v[200:201], v106 offset:8192
    s_waitcnt lgkmcnt(14)
    ds_read_b64_tr_b16 v[202:203], v106 offset:9216
    s_waitcnt lgkmcnt(14)
    ds_read_b64_tr_b16 v[204:205], v107 offset:8192
    s_waitcnt lgkmcnt(14)
    ds_read_b64_tr_b16 v[206:207], v107 offset:9216
    s_waitcnt lgkmcnt(8)
    v_mfma_f32_32x32x16_bf16 v[0:15], v[208:211], v[164:167], v[0:15]
    s_add_u32 m0, s30, 65536
    s_add_u32 s33, s28, 3670016
    buffer_load_dwordx4 v240, s[16:19], s33 offen lds
    v_mfma_f32_32x32x16_bf16 v[16:31], v[212:215], v[164:167], v[16:31]
    v_mfma_f32_32x32x16_bf16 v[32:47], v[216:219], v[164:167], v[32:47]
    s_add_u32 m0, s30, 66560
    s_add_u32 s33, s28, 3702784
    buffer_load_dwordx4 v240, s[16:19], s33 offen lds
    v_mfma_f32_32x32x16_bf16 v[48:63], v[220:223], v[164:167], v[48:63]
    ds_read_b64_tr_b16 v[208:209], v104 offset:12288
    ds_read_b64_tr_b16 v[210:211], v104 offset:13312
    ds_read_b64_tr_b16 v[212:213], v105 offset:12288
    ds_read_b64_tr_b16 v[214:215], v105 offset:13312
    ds_read_b64_tr_b16 v[216:217], v106 offset:12288
    ds_read_b64_tr_b16 v[218:219], v106 offset:13312
    ds_read_b64_tr_b16 v[220:221], v107 offset:12288
    s_waitcnt lgkmcnt(14)
    ds_read_b64_tr_b16 v[222:223], v107 offset:13312
    s_waitcnt lgkmcnt(8)
    v_mfma_f32_32x32x16_bf16 v[0:15], v[192:195], v[168:171], v[0:15]
    s_add_u32 m0, s30, 67584
    s_add_u32 s33, s28, 3735552
    buffer_load_dwordx4 v240, s[16:19], s33 offen lds
    v_mfma_f32_32x32x16_bf16 v[16:31], v[196:199], v[168:171], v[16:31]
    v_mfma_f32_32x32x16_bf16 v[32:47], v[200:203], v[168:171], v[32:47]
    s_add_u32 m0, s30, 68608
    s_add_u32 s33, s28, 3768320
    buffer_load_dwordx4 v240, s[16:19], s33 offen lds
    v_mfma_f32_32x32x16_bf16 v[48:63], v[204:207], v[168:171], v[48:63]
    s_waitcnt lgkmcnt(0)
    s_waitcnt vmcnt(8)
    s_barrier
    ds_read_b128 v[160:163], v108
    ds_read_b64_tr_b16 v[192:193], v96
    ds_read_b64_tr_b16 v[194:195], v96 offset:1024
    ds_read_b64_tr_b16 v[196:197], v97
    ds_read_b64_tr_b16 v[198:199], v97 offset:1024
    ds_read_b64_tr_b16 v[200:201], v98
    ds_read_b64_tr_b16 v[202:203], v98 offset:1024
    ds_read_b64_tr_b16 v[204:205], v99
    ds_read_b64_tr_b16 v[206:207], v99 offset:1024
    v_mfma_f32_32x32x16_bf16 v[0:15], v[208:211], v[172:175], v[0:15]
    s_add_u32 m0, s30, 131072
    s_add_u32 s33, s29, 1024
    buffer_load_dwordx4 v250, s[20:23], s33 offen lds
    v_mfma_f32_32x32x16_bf16 v[16:31], v[212:215], v[172:175], v[16:31]
    v_mfma_f32_32x32x16_bf16 v[32:47], v[216:219], v[172:175], v[32:47]
    s_add_u32 m0, s30, 132096
    s_add_u32 s33, s29, 11264
    buffer_load_dwordx4 v251, s[20:23], s33 offen lds
    v_mfma_f32_32x32x16_bf16 v[48:63], v[220:223], v[172:175], v[48:63]
    ds_read_b128 v[164:167], v109
    ds_read_b128 v[168:171], v110
    ds_read_b128 v[172:175], v111
    s_waitcnt lgkmcnt(3)
    ds_read_b64_tr_b16 v[208:209], v96 offset:4096
    ds_read_b64_tr_b16 v[210:211], v96 offset:5120
    ds_read_b64_tr_b16 v[212:213], v97 offset:4096
    ds_read_b64_tr_b16 v[214:215], v97 offset:5120
    ds_read_b64_tr_b16 v[216:217], v98 offset:4096
    ds_read_b64_tr_b16 v[218:219], v98 offset:5120
    ds_read_b64_tr_b16 v[220:221], v99 offset:4096
    ds_read_b64_tr_b16 v[222:223], v99 offset:5120
    v_mfma_f32_32x32x16_bf16 v[0:15], v[192:195], v[160:163], v[0:15]
    s_add_u32 m0, s30, 133120
    s_add_u32 s33, s29, 21504
    buffer_load_dwordx4 v250, s[20:23], s33 offen lds
    v_mfma_f32_32x32x16_bf16 v[16:31], v[196:199], v[160:163], v[16:31]
    v_mfma_f32_32x32x16_bf16 v[32:47], v[200:203], v[160:163], v[32:47]
    s_add_u32 m0, s30, 134144
    s_add_u32 s33, s29, 31744
    buffer_load_dwordx4 v251, s[20:23], s33 offen lds
    v_mfma_f32_32x32x16_bf16 v[48:63], v[204:207], v[160:163], v[48:63]
    ds_read_b64_tr_b16 v[192:193], v96 offset:8192
    ds_read_b64_tr_b16 v[194:195], v96 offset:9216
    ds_read_b64_tr_b16 v[196:197], v97 offset:8192
    ds_read_b64_tr_b16 v[198:199], v97 offset:9216
    s_waitcnt lgkmcnt(14)
    ds_read_b64_tr_b16 v[200:201], v98 offset:8192
    s_waitcnt lgkmcnt(14)
    ds_read_b64_tr_b16 v[202:203], v98 offset:9216
    s_waitcnt lgkmcnt(14)
    ds_read_b64_tr_b16 v[204:205], v99 offset:8192
    s_waitcnt lgkmcnt(14)
    ds_read_b64_tr_b16 v[206:207], v99 offset:9216
    s_waitcnt lgkmcnt(8)
    v_mfma_f32_32x32x16_bf16 v[0:15], v[208:211], v[164:167], v[0:15]
    s_add_u32 m0, s30, 114688
    s_add_u32 s33, s28, 4194304
    buffer_load_dwordx4 v240, s[16:19], s33 offen lds
    v_mfma_f32_32x32x16_bf16 v[16:31], v[212:215], v[164:167], v[16:31]
    v_mfma_f32_32x32x16_bf16 v[32:47], v[216:219], v[164:167], v[32:47]
    s_add_u32 m0, s30, 115712
    s_add_u32 s33, s28, 4227072
    buffer_load_dwordx4 v240, s[16:19], s33 offen lds
    v_mfma_f32_32x32x16_bf16 v[48:63], v[220:223], v[164:167], v[48:63]
    ds_read_b64_tr_b16 v[208:209], v96 offset:12288
    ds_read_b64_tr_b16 v[210:211], v96 offset:13312
    ds_read_b64_tr_b16 v[212:213], v97 offset:12288
    ds_read_b64_tr_b16 v[214:215], v97 offset:13312
    ds_read_b64_tr_b16 v[216:217], v98 offset:12288
    ds_read_b64_tr_b16 v[218:219], v98 offset:13312
    ds_read_b64_tr_b16 v[220:221], v99 offset:12288
    s_waitcnt lgkmcnt(14)
    ds_read_b64_tr_b16 v[222:223], v99 offset:13312
    s_waitcnt lgkmcnt(8)
    v_mfma_f32_32x32x16_bf16 v[0:15], v[192:195], v[168:171], v[0:15]
    s_add_u32 m0, s30, 116736
    s_add_u32 s33, s28, 4259840
    buffer_load_dwordx4 v240, s[16:19], s33 offen lds
    v_mfma_f32_32x32x16_bf16 v[16:31], v[196:199], v[168:171], v[16:31]
    v_mfma_f32_32x32x16_bf16 v[32:47], v[200:203], v[168:171], v[32:47]
    s_add_u32 m0, s30, 117760
    s_add_u32 s33, s28, 4292608
    buffer_load_dwordx4 v240, s[16:19], s33 offen lds
    v_mfma_f32_32x32x16_bf16 v[48:63], v[204:207], v[168:171], v[48:63]
    s_waitcnt lgkmcnt(0)
    s_waitcnt vmcnt(8)
    s_barrier
    ds_read_b128 v[160:163], v112
    ds_read_b64_tr_b16 v[192:193], v100
    ds_read_b64_tr_b16 v[194:195], v100 offset:1024
    ds_read_b64_tr_b16 v[196:197], v101
    ds_read_b64_tr_b16 v[198:199], v101 offset:1024
    ds_read_b64_tr_b16 v[200:201], v102
    ds_read_b64_tr_b16 v[202:203], v102 offset:1024
    ds_read_b64_tr_b16 v[204:205], v103
    ds_read_b64_tr_b16 v[206:207], v103 offset:1024
    v_mfma_f32_32x32x16_bf16 v[0:15], v[208:211], v[172:175], v[0:15]
    s_add_u32 m0, s30, 32768
    s_add_u32 s33, s29, 1152
    buffer_load_dwordx4 v250, s[20:23], s33 offen lds
    v_mfma_f32_32x32x16_bf16 v[16:31], v[212:215], v[172:175], v[16:31]
    v_mfma_f32_32x32x16_bf16 v[32:47], v[216:219], v[172:175], v[32:47]
    s_add_u32 m0, s30, 33792
    s_add_u32 s33, s29, 11392
    buffer_load_dwordx4 v251, s[20:23], s33 offen lds
    v_mfma_f32_32x32x16_bf16 v[48:63], v[220:223], v[172:175], v[48:63]
    ds_read_b128 v[164:167], v113
    ds_read_b128 v[168:171], v114
    ds_read_b128 v[172:175], v115
    s_waitcnt lgkmcnt(3)
    ds_read_b64_tr_b16 v[208:209], v100 offset:4096
    ds_read_b64_tr_b16 v[210:211], v100 offset:5120
    ds_read_b64_tr_b16 v[212:213], v101 offset:4096
    ds_read_b64_tr_b16 v[214:215], v101 offset:5120
    ds_read_b64_tr_b16 v[216:217], v102 offset:4096
    ds_read_b64_tr_b16 v[218:219], v102 offset:5120
    ds_read_b64_tr_b16 v[220:221], v103 offset:4096
    ds_read_b64_tr_b16 v[222:223], v103 offset:5120
    v_mfma_f32_32x32x16_bf16 v[0:15], v[192:195], v[160:163], v[0:15]
    s_add_u32 m0, s30, 34816
    s_add_u32 s33, s29, 21632
    buffer_load_dwordx4 v250, s[20:23], s33 offen lds
    v_mfma_f32_32x32x16_bf16 v[16:31], v[196:199], v[160:163], v[16:31]
    v_mfma_f32_32x32x16_bf16 v[32:47], v[200:203], v[160:163], v[32:47]
    s_add_u32 m0, s30, 35840
    s_add_u32 s33, s29, 31872
    buffer_load_dwordx4 v251, s[20:23], s33 offen lds
    v_mfma_f32_32x32x16_bf16 v[48:63], v[204:207], v[160:163], v[48:63]
    ds_read_b64_tr_b16 v[192:193], v100 offset:8192
    ds_read_b64_tr_b16 v[194:195], v100 offset:9216
    ds_read_b64_tr_b16 v[196:197], v101 offset:8192
    ds_read_b64_tr_b16 v[198:199], v101 offset:9216
    s_waitcnt lgkmcnt(14)
    ds_read_b64_tr_b16 v[200:201], v102 offset:8192
    s_waitcnt lgkmcnt(14)
    ds_read_b64_tr_b16 v[202:203], v102 offset:9216
    s_waitcnt lgkmcnt(14)
    ds_read_b64_tr_b16 v[204:205], v103 offset:8192
    s_waitcnt lgkmcnt(14)
    ds_read_b64_tr_b16 v[206:207], v103 offset:9216
    s_waitcnt lgkmcnt(8)
    v_mfma_f32_32x32x16_bf16 v[0:15], v[208:211], v[164:167], v[0:15]
    s_add_u32 m0, s30, 16384
    s_add_u32 s33, s28, 4718592
    buffer_load_dwordx4 v240, s[16:19], s33 offen lds
    v_mfma_f32_32x32x16_bf16 v[16:31], v[212:215], v[164:167], v[16:31]
    v_mfma_f32_32x32x16_bf16 v[32:47], v[216:219], v[164:167], v[32:47]
    s_add_u32 m0, s30, 17408
    s_add_u32 s33, s28, 4751360
    buffer_load_dwordx4 v240, s[16:19], s33 offen lds
    v_mfma_f32_32x32x16_bf16 v[48:63], v[220:223], v[164:167], v[48:63]
    ds_read_b64_tr_b16 v[208:209], v100 offset:12288
    ds_read_b64_tr_b16 v[210:211], v100 offset:13312
    ds_read_b64_tr_b16 v[212:213], v101 offset:12288
    ds_read_b64_tr_b16 v[214:215], v101 offset:13312
    ds_read_b64_tr_b16 v[216:217], v102 offset:12288
    ds_read_b64_tr_b16 v[218:219], v102 offset:13312
    ds_read_b64_tr_b16 v[220:221], v103 offset:12288
    s_waitcnt lgkmcnt(14)
    ds_read_b64_tr_b16 v[222:223], v103 offset:13312
    s_waitcnt lgkmcnt(8)
    v_mfma_f32_32x32x16_bf16 v[0:15], v[192:195], v[168:171], v[0:15]
    s_add_u32 m0, s30, 18432
    s_add_u32 s33, s28, 4784128
    buffer_load_dwordx4 v240, s[16:19], s33 offen lds
    v_mfma_f32_32x32x16_bf16 v[16:31], v[196:199], v[168:171], v[16:31]
    v_mfma_f32_32x32x16_bf16 v[32:47], v[200:203], v[168:171], v[32:47]
    s_add_u32 m0, s30, 19456
    s_add_u32 s33, s28, 4816896
    buffer_load_dwordx4 v240, s[16:19], s33 offen lds
    v_mfma_f32_32x32x16_bf16 v[48:63], v[204:207], v[168:171], v[48:63]
    s_waitcnt lgkmcnt(0)
    s_waitcnt vmcnt(8)
    s_barrier
    ds_read_b128 v[160:163], v116
    ds_read_b64_tr_b16 v[192:193], v104
    ds_read_b64_tr_b16 v[194:195], v104 offset:1024
    ds_read_b64_tr_b16 v[196:197], v105
    ds_read_b64_tr_b16 v[198:199], v105 offset:1024
    ds_read_b64_tr_b16 v[200:201], v106
    ds_read_b64_tr_b16 v[202:203], v106 offset:1024
    ds_read_b64_tr_b16 v[204:205], v107
    ds_read_b64_tr_b16 v[206:207], v107 offset:1024
    v_mfma_f32_32x32x16_bf16 v[0:15], v[208:211], v[172:175], v[0:15]
    s_mov_b32 m0, s32
    s_nop 0
    buffer_load_dwordx4 v245, s[8:11], s31 offen nt lds
    v_mfma_f32_32x32x16_bf16 v[16:31], v[212:215], v[172:175], v[16:31]
    v_mfma_f32_32x32x16_bf16 v[32:47], v[216:219], v[172:175], v[32:47]
    buffer_load_dwordx4 v246, s[8:11], s31 offen offset:1024 nt lds
    v_mfma_f32_32x32x16_bf16 v[48:63], v[220:223], v[172:175], v[48:63]
    ds_read_b128 v[164:167], v117
    ds_read_b128 v[168:171], v118
    ds_read_b128 v[172:175], v119
    s_waitcnt lgkmcnt(3)
    ds_read_b64_tr_b16 v[208:209], v104 offset:4096
    ds_read_b64_tr_b16 v[210:211], v104 offset:5120
    ds_read_b64_tr_b16 v[212:213], v105 offset:4096
    ds_read_b64_tr_b16 v[214:215], v105 offset:5120
    ds_read_b64_tr_b16 v[216:217], v106 offset:4096
    ds_read_b64_tr_b16 v[218:219], v106 offset:5120
    ds_read_b64_tr_b16 v[220:221], v107 offset:4096
    ds_read_b64_tr_b16 v[222:223], v107 offset:5120
    v_mfma_f32_32x32x16_bf16 v[0:15], v[192:195], v[160:163], v[0:15]
    buffer_load_dwordx4 v247, s[8:11], s31 offen offset:2048 nt lds
    v_mfma_f32_32x32x16_bf16 v[16:31], v[196:199], v[160:163], v[16:31]
    v_mfma_f32_32x32x16_bf16 v[32:47], v[200:203], v[160:163], v[32:47]
    buffer_load_dwordx4 v248, s[8:11], s31 offen offset:3072 nt lds
    v_mfma_f32_32x32x16_bf16 v[48:63], v[204:207], v[160:163], v[48:63]
    ds_read_b64_tr_b16 v[192:193], v104 offset:8192
    ds_read_b64_tr_b16 v[194:195], v104 offset:9216
    ds_read_b64_tr_b16 v[196:197], v105 offset:8192
    ds_read_b64_tr_b16 v[198:199], v105 offset:9216
    s_waitcnt lgkmcnt(14)
    ds_read_b64_tr_b16 v[200:201], v106 offset:8192
    s_waitcnt lgkmcnt(14)
    ds_read_b64_tr_b16 v[202:203], v106 offset:9216
    s_waitcnt lgkmcnt(14)
    ds_read_b64_tr_b16 v[204:205], v107 offset:8192
    s_waitcnt lgkmcnt(14)
    ds_read_b64_tr_b16 v[206:207], v107 offset:9216
    s_waitcnt lgkmcnt(8)
    v_mfma_f32_32x32x16_bf16 v[0:15], v[208:211], v[164:167], v[0:15]
    s_add_u32 m0, s32, 16384
    s_nop 0
    buffer_load_dwordx4 v249, s[12:15], s31 offen nt lds
    v_mfma_f32_32x32x16_bf16 v[16:31], v[212:215], v[164:167], v[16:31]
    v_mfma_f32_32x32x16_bf16 v[32:47], v[216:219], v[164:167], v[32:47]
    buffer_load_dwordx4 v249, s[12:15], s31 offen offset:1024 nt lds
    v_mfma_f32_32x32x16_bf16 v[48:63], v[220:223], v[164:167], v[48:63]
    ds_read_b64_tr_b16 v[208:209], v104 offset:12288
    ds_read_b64_tr_b16 v[210:211], v104 offset:13312
    ds_read_b64_tr_b16 v[212:213], v105 offset:12288
    ds_read_b64_tr_b16 v[214:215], v105 offset:13312
    ds_read_b64_tr_b16 v[216:217], v106 offset:12288
    ds_read_b64_tr_b16 v[218:219], v106 offset:13312
    ds_read_b64_tr_b16 v[220:221], v107 offset:12288
    s_waitcnt lgkmcnt(14)
    ds_read_b64_tr_b16 v[222:223], v107 offset:13312
    s_waitcnt lgkmcnt(8)
    v_mfma_f32_32x32x16_bf16 v[0:15], v[192:195], v[168:171], v[0:15]
    buffer_load_dwordx4 v249, s[12:15], s31 offen offset:2048 nt lds
    v_mfma_f32_32x32x16_bf16 v[16:31], v[196:199], v[168:171], v[16:31]
    v_mfma_f32_32x32x16_bf16 v[32:47], v[200:203], v[168:171], v[32:47]
    buffer_load_dwordx4 v249, s[12:15], s31 offen offset:3072 nt lds
    s_add_u32 s31, s31, 16384
    s_add_u32 s34, s34, 1
    s_cmp_eq_u32 s34, 16
    s_cselect_b32 s33, 0x3c0000, 0
    s_add_u32 s31, s31, s33
    s_cmp_ge_u32 s34, 32
    s_cselect_b32 s31, 0x8000000, s31
    s_add_u32 s32, s32, 32768
    s_cmp_ge_u32 s32, 163840
    s_cselect_b32 s33, 98304, 0
    s_sub_u32 s32, s32, s33
    v_mfma_f32_32x32x16_bf16 v[48:63], v[204:207], v[168:171], v[48:63]
    s_waitcnt lgkmcnt(0)
    s_waitcnt vmcnt(8)
    s_barrier
    ds_read_b128 v[160:163], v108
    ds_read_b64_tr_b16 v[192:193], v96
    ds_read_b64_tr_b16 v[194:195], v96 offset:1024
    ds_read_b64_tr_b16 v[196:197], v97
    ds_read_b64_tr_b16 v[198:199], v97 offset:1024
    ds_read_b64_tr_b16 v[200:201], v98
    ds_read_b64_tr_b16 v[202:203], v98 offset:1024
    ds_read_b64_tr_b16 v[204:205], v99
    ds_read_b64_tr_b16 v[206:207], v99 offset:1024
    v_mfma_f32_32x32x16_bf16 v[0:15], v[208:211], v[172:175], v[0:15]
    s_mov_b32 m0, s32
    s_nop 0
    buffer_load_dwordx4 v245, s[8:11], s31 offen nt lds
    v_mfma_f32_32x32x16_bf16 v[16:31], v[212:215], v[172:175], v[16:31]
    buffer_load_dwordx4 v246, s[8:11], s31 offen offset:1024 nt lds
    v_mfma_f32_32x32x16_bf16 v[32:47], v[216:219], v[172:175], v[32:47]
    buffer_load_dwordx4 v247, s[8:11], s31 offen offset:2048 nt lds
    v_mfma_f32_32x32x16_bf16 v[48:63], v[220:223], v[172:175], v[48:63]
    buffer_load_dwordx4 v248, s[8:11], s31 offen offset:3072 nt lds
    ds_read_b128 v[164:167], v109
    ds_read_b128 v[168:171], v110
    ds_read_b128 v[172:175], v111
    s_waitcnt lgkmcnt(3)
    ds_read_b64_tr_b16 v[208:209], v96 offset:4096
    ds_read_b64_tr_b16 v[210:211], v96 offset:5120
    ds_read_b64_tr_b16 v[212:213], v97 offset:4096
    ds_read_b64_tr_b16 v[214:215], v97 offset:5120
    ds_read_b64_tr_b16 v[216:217], v98 offset:4096
    ds_read_b64_tr_b16 v[218:219], v98 offset:5120
    ds_read_b64_tr_b16 v[220:221], v99 offset:4096
    ds_read_b64_tr_b16 v[222:223], v99 offset:5120
    v_mfma_f32_32x32x16_bf16 v[0:15], v[192:195], v[160:163], v[0:15]
    s_add_u32 m0, s32, 16384
    s_nop 0
    buffer_load_dwordx4 v249, s[12:15], s31 offen nt lds
    v_mfma_f32_32x32x16_bf16 v[16:31], v[196:199], v[160:163], v[16:31]
    buffer_load_dwordx4 v249, s[12:15], s31 offen offset:1024 nt lds
    v_mfma_f32_32x32x16_bf16 v[32:47], v[200:203], v[160:163], v[32:47]
    buffer_load_dwordx4 v249, s[12:15], s31 offen offset:2048 nt lds
    v_mfma_f32_32x32x16_bf16 v[48:63], v[204:207], v[160:163], v[48:63]
    buffer_load_dwordx4 v249, s[12:15], s31 offen offset:3072 nt lds
    s_add_u32 s31, s31, 16384
    s_add_u32 s34, s34, 1
    s_cmp_eq_u32 s34, 16
    s_cselect_b32 s33, 0x3c0000, 0
    s_add_u32 s31, s31, s33
    s_cmp_ge_u32 s34, 32
    s_cselect_b32 s31, 0x8000000, s31
    s_add_u32 s32, s32, 32768
    s_cmp_ge_u32 s32, 163840
    s_cselect_b32 s33, 98304, 0
    s_sub_u32 s32, s32, s33
    ds_read_b64_tr_b16 v[192:193], v96 offset:8192
    ds_read_b64_tr_b16 v[194:195], v96 offset:9216
    ds_read_b64_tr_b16 v[196:197], v97 offset:8192
    ds_read_b64_tr_b16 v[198:199], v97 offset:9216
    s_waitcnt lgkmcnt(14)
    ds_read_b64_tr_b16 v[200:201], v98 offset:8192
    s_waitcnt lgkmcnt(14)
    ds_read_b64_tr_b16 v[202:203], v98 offset:9216
    s_waitcnt lgkmcnt(14)
    ds_read_b64_tr_b16 v[204:205], v99 offset:8192
    s_waitcnt lgkmcnt(14)
    ds_read_b64_tr_b16 v[206:207], v99 offset:9216
    s_waitcnt lgkmcnt(8)
    v_mfma_f32_32x32x16_bf16 v[0:15], v[208:211], v[164:167], v[0:15]
    s_mov_b32 m0, s32
    s_nop 0
    buffer_load_dwordx4 v245, s[8:11], s31 offen nt lds
    v_mfma_f32_32x32x16_bf16 v[16:31], v[212:215], v[164:167], v[16:31]
    buffer_load_dwordx4 v246, s[8:11], s31 offen offset:1024 nt lds
    v_mfma_f32_32x32x16_bf16 v[32:47], v[216:219], v[164:167], v[32:47]
    buffer_load_dwordx4 v247, s[8:11], s31 offen offset:2048 nt lds
    v_mfma_f32_32x32x16_bf16 v[48:63], v[220:223], v[164:167], v[48:63]
    buffer_load_dwordx4 v248, s[8:11], s31 offen offset:3072 nt lds
    ds_read_b64_tr_b16 v[208:209], v96 offset:12288
    ds_read_b64_tr_b16 v[210:211], v96 offset:13312
    ds_read_b64_tr_b16 v[212:213], v97 offset:12288
    ds_read_b64_tr_b16 v[214:215], v97 offset:13312
    ds_read_b64_tr_b16 v[216:217], v98 offset:12288
    ds_read_b64_tr_b16 v[218:219], v98 offset:13312
    ds_read_b64_tr_b16 v[220:221], v99 offset:12288
    s_waitcnt lgkmcnt(14)
    ds_read_b64_tr_b16 v[222:223], v99 offset:13312
    s_waitcnt lgkmcnt(8)
    v_mfma_f32_32x32x16_bf16 v[0:15], v[192:195], v[168:171], v[0:15]
    s_add_u32 m0, s32, 16384
    s_nop 0
    buffer_load_dwordx4 v249, s[12:15], s31 offen nt lds
    v_mfma_f32_32x32x16_bf16 v[16:31], v[196:199], v[168:171], v[16:31]
    buffer_load_dwordx4 v249, s[12:15], s31 offen offset:1024 nt lds
    v_mfma_f32_32x32x16_bf16 v[32:47], v[200:203], v[168:171], v[32:47]
    buffer_load_dwordx4 v249, s[12:15], s31 offen offset:2048 nt lds
    v_mfma_f32_32x32x16_bf16 v[48:63], v[204:207], v[168:171], v[48:63]
    buffer_load_dwordx4 v249, s[12:15], s31 offen offset:3072 nt lds
    s_add_u32 s31, s31, 16384
    s_add_u32 s34, s34, 1
    s_cmp_eq_u32 s34, 16
    s_cselect_b32 s33, 0x3c0000, 0
    s_add_u32 s31, s31, s33
    s_cmp_ge_u32 s34, 32
    s_cselect_b32 s31, 0x8000000, s31
    s_add_u32 s32, s32, 32768
    s_cmp_ge_u32 s32, 163840
    s_cselect_b32 s33, 98304, 0
    s_sub_u32 s32, s32, s33
    s_waitcnt lgkmcnt(0)
    v_mfma_f32_32x32x16_bf16 v[0:15], v[208:211], v[172:175], v[0:15]
    v_mfma_f32_32x32x16_bf16 v[16:31], v[212:215], v[172:175], v[16:31]
    v_mfma_f32_32x32x16_bf16 v[32:47], v[216:219], v[172:175], v[32:47]
    v_mfma_f32_32x32x16_bf16 v[48:63], v[220:223], v[172:175], v[48:63]
    s_nop 8
    v_mul_f32 v0, s48, v0
    v_mul_f32 v1, s48, v1
    v_mul_f32 v2, s48, v2
    v_mul_f32 v3, s48, v3
    v_mul_f32 v4, s48, v4
    v_mul_f32 v5, s48, v5
    v_mul_f32 v6, s48, v6
    v_mul_f32 v7, s48, v7
    v_cvt_pk_bf16_f32 v128, v0, v1
    v_cvt_pk_bf16_f32 v129, v2, v3
    v_cvt_pk_bf16_f32 v130, v4, v5
    v_cvt_pk_bf16_f32 v131, v6, v7
    v_mul_f32 v8, s48, v8
    v_mul_f32 v9, s48, v9
    v_mul_f32 v10, s48, v10
    v_mul_f32 v11, s48, v11
    v_mul_f32 v12, s48, v12
    v_mul_f32 v13, s48, v13
    v_mul_f32 v14, s48, v14
    v_mul_f32 v15, s48, v15
    v_cvt_pk_bf16_f32 v132, v8, v9
    v_cvt_pk_bf16_f32 v133, v10, v11
    v_cvt_pk_bf16_f32 v134, v12, v13
    v_cvt_pk_bf16_f32 v135, v14, v15
    v_mul_f32 v16, s48, v16
    v_mul_f32 v17, s48, v17
    v_mul_f32 v18, s48, v18
    v_mul_f32 v19, s48, v19
    v_mul_f32 v20, s48, v20
    v_mul_f32 v21, s48, v21
    v_mul_f32 v22, s48, v22
    v_mul_f32 v23, s48, v23
    v_cvt_pk_bf16_f32 v136, v16, v17
    v_cvt_pk_bf16_f32 v137, v18, v19
    v_cvt_pk_bf16_f32 v138, v20, v21
    v_cvt_pk_bf16_f32 v139, v22, v23
    v_mul_f32 v24, s48, v24
    v_mul_f32 v25, s48, v25
    v_mul_f32 v26, s48, v26
    v_mul_f32 v27, s48, v27
    v_mul_f32 v28, s48, v28
    v_mul_f32 v29, s48, v29
    v_mul_f32 v30, s48, v30
    v_mul_f32 v31, s48, v31
    v_cvt_pk_bf16_f32 v140, v24, v25
    v_cvt_pk_bf16_f32 v141, v26, v27
    v_cvt_pk_bf16_f32 v142, v28, v29
    v_cvt_pk_bf16_f32 v143, v30, v31
    v_mul_f32 v32, s48, v32
    v_mul_f32 v33, s48, v33
    v_mul_f32 v34, s48, v34
    v_mul_f32 v35, s48, v35
    v_mul_f32 v36, s48, v36
    v_mul_f32 v37, s48, v37
    v_mul_f32 v38, s48, v38
    v_mul_f32 v39, s48, v39
    v_cvt_pk_bf16_f32 v144, v32, v33
    v_cvt_pk_bf16_f32 v145, v34, v35
    v_cvt_pk_bf16_f32 v146, v36, v37
    v_cvt_pk_bf16_f32 v147, v38, v39
    v_mul_f32 v40, s48, v40
    v_mul_f32 v41, s48, v41
    v_mul_f32 v42, s48, v42
    v_mul_f32 v43, s48, v43
    v_mul_f32 v44, s48, v44
    v_mul_f32 v45, s48, v45
    v_mul_f32 v46, s48, v46
    v_mul_f32 v47, s48, v47
    v_cvt_pk_bf16_f32 v148, v40, v41
    v_cvt_pk_bf16_f32 v149, v42, v43
    v_cvt_pk_bf16_f32 v150, v44, v45
    v_cvt_pk_bf16_f32 v151, v46, v47
    v_mul_f32 v48, s48, v48
    v_mul_f32 v49, s48, v49
    v_mul_f32 v50, s48, v50
    v_mul_f32 v51, s48, v51
    v_mul_f32 v52, s48, v52
    v_mul_f32 v53, s48, v53
    v_mul_f32 v54, s48, v54
    v_mul_f32 v55, s48, v55
    v_cvt_pk_bf16_f32 v152, v48, v49
    v_cvt_pk_bf16_f32 v153, v50, v51
    v_cvt_pk_bf16_f32 v154, v52, v53
    v_cvt_pk_bf16_f32 v155, v54, v55
    v_mul_f32 v56, s48, v56
    v_mul_f32 v57, s48, v57
    v_mul_f32 v58, s48, v58
    v_mul_f32 v59, s48, v59
    v_mul_f32 v60, s48, v60
    v_mul_f32 v61, s48, v61
    v_mul_f32 v62, s48, v62
    v_mul_f32 v63, s48, v63
    v_cvt_pk_bf16_f32 v156, v56, v57
    v_cvt_pk_bf16_f32 v157, v58, v59
    v_cvt_pk_bf16_f32 v158, v60, v61
    v_cvt_pk_bf16_f32 v159, v62, v63
    s_waitcnt vmcnt(16)
    s_barrier
    s_waitcnt vmcnt(8)
    s_barrier
    s_mov_b32 m0, s32
    s_nop 0
    buffer_load_dwordx4 v245, s[8:11], s31 offen nt lds
    buffer_load_dwordx4 v246, s[8:11], s31 offen offset:1024 nt lds
    buffer_load_dwordx4 v247, s[8:11], s31 offen offset:2048 nt lds
    buffer_load_dwordx4 v248, s[8:11], s31 offen offset:3072 nt lds
    s_add_u32 m0, s32, 16384
    s_nop 0
    buffer_load_dwordx4 v249, s[12:15], s31 offen nt lds
    buffer_load_dwordx4 v249, s[12:15], s31 offen offset:1024 nt lds
    buffer_load_dwordx4 v249, s[12:15], s31 offen offset:2048 nt lds
    buffer_load_dwordx4 v249, s[12:15], s31 offen offset:3072 nt lds
    s_add_u32 s31, s31, 16384
    s_add_u32 s34, s34, 1
    s_cmp_eq_u32 s34, 16
    s_cselect_b32 s33, 0x3c0000, 0
    s_add_u32 s31, s31, s33
    s_cmp_ge_u32 s34, 32
    s_cselect_b32 s31, 0x8000000, s31
    s_add_u32 s32, s32, 32768
    s_cmp_ge_u32 s32, 163840
    s_cselect_b32 s33, 98304, 0
    s_sub_u32 s32, s32, s33
    s_waitcnt vmcnt(8)
    s_barrier
    s_mov_b32 m0, s32
    s_nop 0
    buffer_load_dwordx4 v245, s[8:11], s31 offen nt lds
    buffer_load_dwordx4 v246, s[8:11], s31 offen offset:1024 nt lds
    buffer_load_dwordx4 v247, s[8:11], s31 offen offset:2048 nt lds
    buffer_load_dwordx4 v248, s[8:11], s31 offen offset:3072 nt lds
    s_add_u32 m0, s32, 16384
    s_nop 0
    buffer_load_dwordx4 v249, s[12:15], s31 offen nt lds
    buffer_load_dwordx4 v249, s[12:15], s31 offen offset:1024 nt lds
    buffer_load_dwordx4 v249, s[12:15], s31 offen offset:2048 nt lds
    buffer_load_dwordx4 v249, s[12:15], s31 offen offset:3072 nt lds
    s_add_u32 s31, s31, 16384
    s_add_u32 s34, s34, 1
    s_cmp_eq_u32 s34, 16
    s_cselect_b32 s33, 0x3c0000, 0
    s_add_u32 s31, s31, s33
    s_cmp_ge_u32 s34, 32
    s_cselect_b32 s31, 0x8000000, s31
    s_add_u32 s32, s32, 32768
    s_cmp_ge_u32 s32, 163840
    s_cselect_b32 s33, 98304, 0
    s_sub_u32 s32, s32, s33
    s_waitcnt vmcnt(8)
    s_barrier
    s_mov_b32 m0, s32
    s_nop 0
    buffer_load_dwordx4 v245, s[8:11], s31 offen nt lds
    buffer_load_dwordx4 v246, s[8:11], s31 offen offset:1024 nt lds
    buffer_load_dwordx4 v247, s[8:11], s31 offen offset:2048 nt lds
    buffer_load_dwordx4 v248, s[8:11], s31 offen offset:3072 nt lds
    s_add_u32 m0, s32, 16384
    s_nop 0
    buffer_load_dwordx4 v249, s[12:15], s31 offen nt lds
    buffer_load_dwordx4 v249, s[12:15], s31 offen offset:1024 nt lds
    buffer_load_dwordx4 v249, s[12:15], s31 offen offset:2048 nt lds
    buffer_load_dwordx4 v249, s[12:15], s31 offen offset:3072 nt lds
    s_add_u32 s31, s31, 16384
    s_add_u32 s34, s34, 1
    s_cmp_eq_u32 s34, 16
    s_cselect_b32 s33, 0x3c0000, 0
    s_add_u32 s31, s31, s33
    s_cmp_ge_u32 s34, 32
    s_cselect_b32 s31, 0x8000000, s31
    s_add_u32 s32, s32, 32768
    s_cmp_ge_u32 s32, 163840
    s_cselect_b32 s33, 98304, 0
    s_sub_u32 s32, s32, s33
    s_waitcnt vmcnt(8)
    s_barrier
    s_mov_b32 m0, s32
    s_nop 0
    buffer_load_dwordx4 v245, s[8:11], s31 offen nt lds
    buffer_load_dwordx4 v246, s[8:11], s31 offen offset:1024 nt lds
    buffer_load_dwordx4 v247, s[8:11], s31 offen offset:2048 nt lds
    buffer_load_dwordx4 v248, s[8:11], s31 offen offset:3072 nt lds
    s_add_u32 m0, s32, 16384
    s_nop 0
    buffer_load_dwordx4 v249, s[12:15], s31 offen nt lds
    buffer_load_dwordx4 v249, s[12:15], s31 offen offset:1024 nt lds
    buffer_load_dwordx4 v249, s[12:15], s31 offen offset:2048 nt lds
    buffer_load_dwordx4 v249, s[12:15], s31 offen offset:3072 nt lds
    s_add_u32 s31, s31, 16384
    s_add_u32 s34, s34, 1
    s_cmp_eq_u32 s34, 16
    s_cselect_b32 s33, 0x3c0000, 0
    s_add_u32 s31, s31, s33
    s_cmp_ge_u32 s34, 32
    s_cselect_b32 s31, 0x8000000, s31
    s_add_u32 s32, s32, 32768
    s_cmp_ge_u32 s32, 163840
    s_cselect_b32 s33, 98304, 0
    s_sub_u32 s32, s32, s33
    s_waitcnt vmcnt(8)
    s_barrier
    s_mov_b32 m0, s32
    s_nop 0
    buffer_load_dwordx4 v245, s[8:11], s31 offen nt lds
    buffer_load_dwordx4 v246, s[8:11], s31 offen offset:1024 nt lds
    buffer_load_dwordx4 v247, s[8:11], s31 offen offset:2048 nt lds
    buffer_load_dwordx4 v248, s[8:11], s31 offen offset:3072 nt lds
    s_add_u32 m0, s32, 16384
    s_nop 0
    buffer_load_dwordx4 v249, s[12:15], s31 offen nt lds
    buffer_load_dwordx4 v249, s[12:15], s31 offen offset:1024 nt lds
    buffer_load_dwordx4 v249, s[12:15], s31 offen offset:2048 nt lds
    buffer_load_dwordx4 v249, s[12:15], s31 offen offset:3072 nt lds
    s_add_u32 s31, s31, 16384
    s_add_u32 s34, s34, 1
    s_cmp_eq_u32 s34, 16
    s_cselect_b32 s33, 0x3c0000, 0
    s_add_u32 s31, s31, s33
    s_cmp_ge_u32 s34, 32
    s_cselect_b32 s31, 0x8000000, s31
    s_add_u32 s32, s32, 32768
    s_cmp_ge_u32 s32, 163840
    s_cselect_b32 s33, 98304, 0
    s_sub_u32 s32, s32, s33
    s_waitcnt vmcnt(8)
    s_barrier
    s_mov_b32 m0, s32
    s_nop 0
    buffer_load_dwordx4 v245, s[8:11], s31 offen nt lds
    buffer_load_dwordx4 v246, s[8:11], s31 offen offset:1024 nt lds
    buffer_load_dwordx4 v247, s[8:11], s31 offen offset:2048 nt lds
    buffer_load_dwordx4 v248, s[8:11], s31 offen offset:3072 nt lds
    s_add_u32 m0, s32, 16384
    s_nop 0
    buffer_load_dwordx4 v249, s[12:15], s31 offen nt lds
    buffer_load_dwordx4 v249, s[12:15], s31 offen offset:1024 nt lds
    buffer_load_dwordx4 v249, s[12:15], s31 offen offset:2048 nt lds
    buffer_load_dwordx4 v249, s[12:15], s31 offen offset:3072 nt lds
    s_add_u32 s31, s31, 16384
    s_add_u32 s34, s34, 1
    s_cmp_eq_u32 s34, 16
    s_cselect_b32 s33, 0x3c0000, 0
    s_add_u32 s31, s31, s33
    s_cmp_ge_u32 s34, 32
    s_cselect_b32 s31, 0x8000000, s31
    s_add_u32 s32, s32, 32768
    s_cmp_ge_u32 s32, 163840
    s_cselect_b32 s33, 98304, 0
    s_sub_u32 s32, s32, s33
    s_waitcnt vmcnt(8)
    s_barrier
    s_mov_b32 m0, s32
    s_nop 0
    buffer_load_dwordx4 v245, s[8:11], s31 offen nt lds
    buffer_load_dwordx4 v246, s[8:11], s31 offen offset:1024 nt lds
    buffer_load_dwordx4 v247, s[8:11], s31 offen offset:2048 nt lds
    buffer_load_dwordx4 v248, s[8:11], s31 offen offset:3072 nt lds
    s_add_u32 m0, s32, 16384
    s_nop 0
    buffer_load_dwordx4 v249, s[12:15], s31 offen nt lds
    buffer_load_dwordx4 v249, s[12:15], s31 offen offset:1024 nt lds
    buffer_load_dwordx4 v249, s[12:15], s31 offen offset:2048 nt lds
    buffer_load_dwordx4 v249, s[12:15], s31 offen offset:3072 nt lds
    s_add_u32 s31, s31, 16384
    s_add_u32 s34, s34, 1
    s_cmp_eq_u32 s34, 16
    s_cselect_b32 s33, 0x3c0000, 0
    s_add_u32 s31, s31, s33
    s_cmp_ge_u32 s34, 32
    s_cselect_b32 s31, 0x8000000, s31
    s_add_u32 s32, s32, 32768
    s_cmp_ge_u32 s32, 163840
    s_cselect_b32 s33, 98304, 0
    s_sub_u32 s32, s32, s33
    s_waitcnt vmcnt(8)
    s_barrier
    s_mov_b32 m0, s32
    s_nop 0
    buffer_load_dwordx4 v245, s[8:11], s31 offen nt lds
    buffer_load_dwordx4 v246, s[8:11], s31 offen offset:1024 nt lds
    buffer_load_dwordx4 v247, s[8:11], s31 offen offset:2048 nt lds
    buffer_load_dwordx4 v248, s[8:11], s31 offen offset:3072 nt lds
    s_add_u32 m0, s32, 16384
    s_nop 0
    buffer_load_dwordx4 v249, s[12:15], s31 offen nt lds
    buffer_load_dwordx4 v249, s[12:15], s31 offen offset:1024 nt lds
    buffer_load_dwordx4 v249, s[12:15], s31 offen offset:2048 nt lds
    buffer_load_dwordx4 v249, s[12:15], s31 offen offset:3072 nt lds
    s_add_u32 s31, s31, 16384
    s_add_u32 s34, s34, 1
    s_cmp_eq_u32 s34, 16
    s_cselect_b32 s33, 0x3c0000, 0
    s_add_u32 s31, s31, s33
    s_cmp_ge_u32 s34, 32
    s_cselect_b32 s31, 0x8000000, s31
    s_add_u32 s32, s32, 32768
    s_cmp_ge_u32 s32, 163840
    s_cselect_b32 s33, 98304, 0
    s_sub_u32 s32, s32, s33
    s_waitcnt vmcnt(8)
    s_barrier
    s_mov_b32 m0, s32
    s_nop 0
    buffer_load_dwordx4 v245, s[8:11], s31 offen nt lds
    buffer_load_dwordx4 v246, s[8:11], s31 offen offset:1024 nt lds
    buffer_load_dwordx4 v247, s[8:11], s31 offen offset:2048 nt lds
    buffer_load_dwordx4 v248, s[8:11], s31 offen offset:3072 nt lds
    s_add_u32 m0, s32, 16384
    s_nop 0
    buffer_load_dwordx4 v249, s[12:15], s31 offen nt lds
    buffer_load_dwordx4 v249, s[12:15], s31 offen offset:1024 nt lds
    buffer_load_dwordx4 v249, s[12:15], s31 offen offset:2048 nt lds
    buffer_load_dwordx4 v249, s[12:15], s31 offen offset:3072 nt lds
    s_add_u32 s31, s31, 16384
    s_add_u32 s34, s34, 1
    s_cmp_eq_u32 s34, 16
    s_cselect_b32 s33, 0x3c0000, 0
    s_add_u32 s31, s31, s33
    s_cmp_ge_u32 s34, 32
    s_cselect_b32 s31, 0x8000000, s31
    s_add_u32 s32, s32, 32768
    s_cmp_ge_u32 s32, 163840
    s_cselect_b32 s33, 98304, 0
    s_sub_u32 s32, s32, s33
    s_waitcnt vmcnt(8)
    s_barrier
    s_mov_b32 m0, s32
    s_nop 0
    buffer_load_dwordx4 v245, s[8:11], s31 offen nt lds
    buffer_load_dwordx4 v246, s[8:11], s31 offen offset:1024 nt lds
    buffer_load_dwordx4 v247, s[8:11], s31 offen offset:2048 nt lds
    buffer_load_dwordx4 v248, s[8:11], s31 offen offset:3072 nt lds
    s_add_u32 m0, s32, 16384
    s_nop 0
    buffer_load_dwordx4 v249, s[12:15], s31 offen nt lds
    buffer_load_dwordx4 v249, s[12:15], s31 offen offset:1024 nt lds
    buffer_load_dwordx4 v249, s[12:15], s31 offen offset:2048 nt lds
    buffer_load_dwordx4 v249, s[12:15], s31 offen offset:3072 nt lds
    s_add_u32 s31, s31, 16384
    s_add_u32 s34, s34, 1
    s_cmp_eq_u32 s34, 16
    s_cselect_b32 s33, 0x3c0000, 0
    s_add_u32 s31, s31, s33
    s_cmp_ge_u32 s34, 32
    s_cselect_b32 s31, 0x8000000, s31
    s_add_u32 s32, s32, 32768
    s_cmp_ge_u32 s32, 163840
    s_cselect_b32 s33, 98304, 0
    s_sub_u32 s32, s32, s33
    s_waitcnt vmcnt(8)
    s_barrier
    s_mov_b32 m0, s32
    s_nop 0
    buffer_load_dwordx4 v245, s[8:11], s31 offen nt lds
    buffer_load_dwordx4 v246, s[8:11], s31 offen offset:1024 nt lds
    buffer_load_dwordx4 v247, s[8:11], s31 offen offset:2048 nt lds
    buffer_load_dwordx4 v248, s[8:11], s31 offen offset:3072 nt lds
    s_add_u32 m0, s32, 16384
    s_nop 0
    buffer_load_dwordx4 v249, s[12:15], s31 offen nt lds
    buffer_load_dwordx4 v249, s[12:15], s31 offen offset:1024 nt lds
    buffer_load_dwordx4 v249, s[12:15], s31 offen offset:2048 nt lds
    buffer_load_dwordx4 v249, s[12:15], s31 offen offset:3072 nt lds
    s_add_u32 s31, s31, 16384
    s_add_u32 s34, s34, 1
    s_cmp_eq_u32 s34, 16
    s_cselect_b32 s33, 0x3c0000, 0
    s_add_u32 s31, s31, s33
    s_cmp_ge_u32 s34, 32
    s_cselect_b32 s31, 0x8000000, s31
    s_add_u32 s32, s32, 32768
    s_cmp_ge_u32 s32, 163840
    s_cselect_b32 s33, 98304, 0
    s_sub_u32 s32, s32, s33
    s_waitcnt vmcnt(8)
    s_barrier
    s_mov_b32 m0, s32
    s_nop 0
    buffer_load_dwordx4 v245, s[8:11], s31 offen nt lds
    buffer_load_dwordx4 v246, s[8:11], s31 offen offset:1024 nt lds
    buffer_load_dwordx4 v247, s[8:11], s31 offen offset:2048 nt lds
    buffer_load_dwordx4 v248, s[8:11], s31 offen offset:3072 nt lds
    s_add_u32 m0, s32, 16384
    s_nop 0
    buffer_load_dwordx4 v249, s[12:15], s31 offen nt lds
    buffer_load_dwordx4 v249, s[12:15], s31 offen offset:1024 nt lds
    buffer_load_dwordx4 v249, s[12:15], s31 offen offset:2048 nt lds
    buffer_load_dwordx4 v249, s[12:15], s31 offen offset:3072 nt lds
    s_add_u32 s31, s31, 16384
    s_add_u32 s34, s34, 1
    s_cmp_eq_u32 s34, 16
    s_cselect_b32 s33, 0x3c0000, 0
    s_add_u32 s31, s31, s33
    s_cmp_ge_u32 s34, 32
    s_cselect_b32 s31, 0x8000000, s31
    s_add_u32 s32, s32, 32768
    s_cmp_ge_u32 s32, 163840
    s_cselect_b32 s33, 98304, 0
    s_sub_u32 s32, s32, s33
    s_waitcnt vmcnt(8)
    s_barrier
    s_mov_b32 s16, s52
    s_and_b32 s17, s53, 0xffff
    s_mov_b32 s18, 0x500000
    s_mov_b32 s19, 0x20000
    v_mbcnt_lo_u32_b32 v72, -1, 0
    v_mbcnt_hi_u32_b32 v72, -1, v72
    s_mov_b32 s33, 0x1999999a
    v_add_u32 v69, 0, v72
    v_mul_hi_u32 v70, v69, s33
    v_mul_u32_u24 v71, 10, v70
    v_sub_u32 v71, v69, v71
    v_mul_u32_u24 v70, 1280, v70
    v_lshl_add_u32 v64, v71, 4, v70
    v_add_u32 v69, 64, v72
    v_mul_hi_u32 v70, v69, s33
    v_mul_u32_u24 v71, 10, v70
    v_sub_u32 v71, v69, v71
    v_mul_u32_u24 v70, 1280, v70
    v_lshl_add_u32 v65, v71, 4, v70
    v_add_u32 v69, 128, v72
    v_mul_hi_u32 v70, v69, s33
    v_mul_u32_u24 v71, 10, v70
    v_sub_u32 v71, v69, v71
    v_mul_u32_u24 v70, 1280, v70
    v_lshl_add_u32 v66, v71, 4, v70
    v_add_u32 v69, 192, v72
    v_mul_hi_u32 v70, v69, s33
    v_mul_u32_u24 v71, 10, v70
    v_sub_u32 v71, v69, v71
    v_mul_u32_u24 v70, 1280, v70
    v_lshl_add_u32 v67, v71, 4, v70
    v_add_u32 v69, 256, v72
    v_mul_hi_u32 v70, v69, s33
    v_mul_u32_u24 v71, 10, v70
    v_sub_u32 v71, v69, v71
    v_mul_u32_u24 v70, 1280, v70
    v_lshl_add_u32 v68, v71, 4, v70
    s_lshr_b32 s35, s2, 1
    s_mul_i32 s35, s35, 40960
    s_and_b32 s33, s2, 1
    s_mul_i32 s33, s33, 640
    s_add_u32 s35, s35, s33
    s_mul_i32 s33, s3, 160
    s_add_u32 s35, s35, s33
    s_mul_i32 s51, s3, 5120
    s_add_u32 s51, s51, 32768
    s_add_u32 m0, s51, 0
    s_nop 0
    buffer_load_dwordx4 v64, s[16:19], s35 offen lds
    s_add_u32 m0, s51, 1024
    s_nop 0
    buffer_load_dwordx4 v65, s[16:19], s35 offen lds
    s_add_u32 m0, s51, 2048
    s_nop 0
    buffer_load_dwordx4 v66, s[16:19], s35 offen lds
    s_add_u32 m0, s51, 3072
    s_nop 0
    buffer_load_dwordx4 v67, s[16:19], s35 offen lds
    s_add_u32 m0, s51, 4096
    s_nop 0
    buffer_load_dwordx4 v68, s[16:19], s35 offen lds
    s_mov_b32 m0, s32
    s_nop 0
    buffer_load_dwordx4 v245, s[8:11], s31 offen nt lds
    buffer_load_dwordx4 v246, s[8:11], s31 offen offset:1024 nt lds
    buffer_load_dwordx4 v247, s[8:11], s31 offen offset:2048 nt lds
    buffer_load_dwordx4 v248, s[8:11], s31 offen offset:3072 nt lds
    s_add_u32 m0, s32, 16384
    s_nop 0
    buffer_load_dwordx4 v249, s[12:15], s31 offen nt lds
    buffer_load_dwordx4 v249, s[12:15], s31 offen offset:1024 nt lds
    buffer_load_dwordx4 v249, s[12:15], s31 offen offset:2048 nt lds
    buffer_load_dwordx4 v249, s[12:15], s31 offen offset:3072 nt lds
    s_add_u32 s31, s31, 16384
    s_add_u32 s34, s34, 1
    s_cmp_eq_u32 s34, 16
    s_cselect_b32 s33, 0x3c0000, 0
    s_add_u32 s31, s31, s33
    s_cmp_ge_u32 s34, 32
    s_cselect_b32 s31, 0x8000000, s31
    s_add_u32 s32, s32, 32768
    s_cmp_ge_u32 s32, 163840
    s_cselect_b32 s33, 98304, 0
    s_sub_u32 s32, s32, s33
    s_waitcnt vmcnt(13)
    s_barrier
    s_waitcnt vmcnt(8)
    v_lshrrev_b32 v64, 5, v72
    v_bfe_u32 v65, v72, 4, 1
    v_bfe_u32 v66, v72, 2, 2
    v_lshl_add_u32 v66, v65, 2, v66
    v_lshl_add_u32 v66, v64, 4, v66
    v_mul_u32_u24 v66, 160, v66
    v_and_b32 v65, 3, v72
    v_lshl_add_u32 v66, v65, 3, v66
    v_add_u32 v66, s51, v66
    ds_read_b64_tr_b16 v[80:81], v66
    ds_read_b64_tr_b16 v[82:83], v66 offset:1280
    ds_read_b64_tr_b16 v[84:85], v66 offset:32
    ds_read_b64_tr_b16 v[86:87], v66 offset:1312
    ds_read_b64_tr_b16 v[88:89], v66 offset:64
    ds_read_b64_tr_b16 v[90:91], v66 offset:1344
    ds_read_b64_tr_b16 v[92:93], v66 offset:96
    ds_read_b64_tr_b16 v[94:95], v66 offset:1376
    ds_read_b64_tr_b16 v[96:97], v66 offset:128
    ds_read_b64_tr_b16 v[98:99], v66 offset:1408
    v_lshlrev_b32 v67, 4, v72
    s_and_b32 s33, s2, 1
    s_mul_i32 s33, s33, 20
    s_mul_i32 s35, s3, 5
    s_add_u32 s33, s33, s35
    s_lshl_b32 s33, s33, 7
    s_lshr_b32 s35, s2, 1
    s_add_u32 s33, s33, s35
    s_lshl_b32 s33, s33, 10
    s_add_u32 s35, s33, 0x1800000
    s_add_u32 s33, s35, 0
    s_waitcnt lgkmcnt(8)
    buffer_store_dwordx4 v[80:83], v67, s[24:27], s33 offen sc0 sc1
    s_add_u32 s33, s35, 131072
    s_waitcnt lgkmcnt(6)
    buffer_store_dwordx4 v[84:87], v67, s[24:27], s33 offen sc0 sc1
    s_add_u32 s33, s35, 262144
    s_waitcnt lgkmcnt(4)
    buffer_store_dwordx4 v[88:91], v67, s[24:27], s33 offen sc0 sc1
    s_add_u32 s33, s35, 393216
    s_waitcnt lgkmcnt(2)
    buffer_store_dwordx4 v[92:95], v67, s[24:27], s33 offen sc0 sc1
    s_add_u32 s33, s35, 524288
    s_waitcnt lgkmcnt(0)
    buffer_store_dwordx4 v[96:99], v67, s[24:27], s33 offen sc0 sc1
    s_mov_b32 m0, s32
    s_nop 0
    buffer_load_dwordx4 v245, s[8:11], s31 offen nt lds
    buffer_load_dwordx4 v246, s[8:11], s31 offen offset:1024 nt lds
    buffer_load_dwordx4 v247, s[8:11], s31 offen offset:2048 nt lds
    buffer_load_dwordx4 v248, s[8:11], s31 offen offset:3072 nt lds
    s_add_u32 m0, s32, 16384
    s_nop 0
    buffer_load_dwordx4 v249, s[12:15], s31 offen nt lds
    buffer_load_dwordx4 v249, s[12:15], s31 offen offset:1024 nt lds
    buffer_load_dwordx4 v249, s[12:15], s31 offen offset:2048 nt lds
    buffer_load_dwordx4 v249, s[12:15], s31 offen offset:3072 nt lds
    s_add_u32 s31, s31, 16384
    s_add_u32 s34, s34, 1
    s_cmp_eq_u32 s34, 16
    s_cselect_b32 s33, 0x3c0000, 0
    s_add_u32 s31, s31, s33
    s_cmp_ge_u32 s34, 32
    s_cselect_b32 s31, 0x8000000, s31
    s_add_u32 s32, s32, 32768
    s_cmp_ge_u32 s32, 163840
    s_cselect_b32 s33, 98304, 0
    s_sub_u32 s32, s32, s33
    s_lshl_b32 s33, s3, 13
    s_add_u32 s33, s33, 0
    v_mbcnt_lo_u32_b32 v224, -1, 0
    v_mbcnt_hi_u32_b32 v224, -1, v224
    v_lshlrev_b32 v224, 4, v224
    v_add_u32 v224, s33, v224
    ds_write_b128 v224, v[128:131]
    ds_write_b128 v224, v[132:135] offset:1024
    ds_write_b128 v224, v[136:139] offset:2048
    ds_write_b128 v224, v[140:143] offset:3072
    ds_write_b128 v224, v[144:147] offset:4096
    ds_write_b128 v224, v[148:151] offset:5120
    ds_write_b128 v224, v[152:155] offset:6144
    ds_write_b128 v224, v[156:159] offset:7168
    s_waitcnt lgkmcnt(0)
    s_waitcnt vmcnt(13)
    s_barrier
    s_mov_b32 m0, s32
    s_nop 0
    buffer_load_dwordx4 v245, s[8:11], s31 offen nt lds
    buffer_load_dwordx4 v246, s[8:11], s31 offen offset:1024 nt lds
    buffer_load_dwordx4 v247, s[8:11], s31 offen offset:2048 nt lds
    buffer_load_dwordx4 v248, s[8:11], s31 offen offset:3072 nt lds
    s_add_u32 m0, s32, 16384
    s_nop 0
    buffer_load_dwordx4 v249, s[12:15], s31 offen nt lds
    buffer_load_dwordx4 v249, s[12:15], s31 offen offset:1024 nt lds
    buffer_load_dwordx4 v249, s[12:15], s31 offen offset:2048 nt lds
    buffer_load_dwordx4 v249, s[12:15], s31 offen offset:3072 nt lds
    s_add_u32 s31, s31, 16384
    s_add_u32 s34, s34, 1
    s_cmp_eq_u32 s34, 16
    s_cselect_b32 s33, 0x3c0000, 0
    s_add_u32 s31, s31, s33
    s_cmp_ge_u32 s34, 32
    s_cselect_b32 s31, 0x8000000, s31
    s_add_u32 s32, s32, 32768
    s_cmp_ge_u32 s32, 163840
    s_cselect_b32 s33, 98304, 0
    s_sub_u32 s32, s32, s33
    s_waitcnt vmcnt(8)
    s_barrier
    s_mov_b32 s16, s58
    s_and_b32 s17, s59, 0xffff
    s_mov_b32 s18, 0x100
    s_mov_b32 s19, 0x20000
    v_mov_b32 v228, 0
    v_mov_b32 v231, 1
    s_cmp_lg_u32 s3, 0
    s_cbranch_scc1 standalone__mha_block_cached__near_ridge_kernel_ns1707
    s_mov_b32 s33, 0
    s_mov_b64 exec, 1
    buffer_atomic_add v231, v228, s[16:19], s33 offen sc1
    s_mov_b64 exec, -1
standalone__mha_block_cached__near_ridge_kernel_ns1707:
    s_mov_b32 m0, s32
    s_nop 0
    buffer_load_dwordx4 v245, s[8:11], s31 offen nt lds
    buffer_load_dwordx4 v246, s[8:11], s31 offen offset:1024 nt lds
    buffer_load_dwordx4 v247, s[8:11], s31 offen offset:2048 nt lds
    buffer_load_dwordx4 v248, s[8:11], s31 offen offset:3072 nt lds
    s_add_u32 m0, s32, 16384
    s_nop 0
    buffer_load_dwordx4 v249, s[12:15], s31 offen nt lds
    buffer_load_dwordx4 v249, s[12:15], s31 offen offset:1024 nt lds
    buffer_load_dwordx4 v249, s[12:15], s31 offen offset:2048 nt lds
    buffer_load_dwordx4 v249, s[12:15], s31 offen offset:3072 nt lds
    s_add_u32 s31, s31, 16384
    s_add_u32 s34, s34, 1
    s_cmp_eq_u32 s34, 16
    s_cselect_b32 s33, 0x3c0000, 0
    s_add_u32 s31, s31, s33
    s_cmp_ge_u32 s34, 32
    s_cselect_b32 s31, 0x8000000, s31
    s_add_u32 s32, s32, 32768
    s_cmp_ge_u32 s32, 163840
    s_cselect_b32 s33, 98304, 0
    s_sub_u32 s32, s32, s33
    s_waitcnt vmcnt(8)
    s_barrier
    s_mov_b32 m0, s32
    s_nop 0
    buffer_load_dwordx4 v245, s[8:11], s31 offen nt lds
    buffer_load_dwordx4 v246, s[8:11], s31 offen offset:1024 nt lds
    buffer_load_dwordx4 v247, s[8:11], s31 offen offset:2048 nt lds
    buffer_load_dwordx4 v248, s[8:11], s31 offen offset:3072 nt lds
    s_add_u32 m0, s32, 16384
    s_nop 0
    buffer_load_dwordx4 v249, s[12:15], s31 offen nt lds
    buffer_load_dwordx4 v249, s[12:15], s31 offen offset:1024 nt lds
    buffer_load_dwordx4 v249, s[12:15], s31 offen offset:2048 nt lds
    buffer_load_dwordx4 v249, s[12:15], s31 offen offset:3072 nt lds
    s_add_u32 s31, s31, 16384
    s_add_u32 s34, s34, 1
    s_cmp_eq_u32 s34, 16
    s_cselect_b32 s33, 0x3c0000, 0
    s_add_u32 s31, s31, s33
    s_cmp_ge_u32 s34, 32
    s_cselect_b32 s31, 0x8000000, s31
    s_add_u32 s32, s32, 32768
    s_cmp_ge_u32 s32, 163840
    s_cselect_b32 s33, 98304, 0
    s_sub_u32 s32, s32, s33
    s_waitcnt vmcnt(8)
    s_barrier
    s_cmp_lg_u32 s3, 0
    s_cbranch_scc1 standalone__mha_block_cached__near_ridge_kernel_ns1766
    s_lshl_b32 s33, s7, 2
    s_add_u32 s33, s33, 64
    s_mov_b64 exec, 1
    buffer_atomic_add v231, v228, s[16:19], s33 offen sc1
    s_mov_b64 exec, -1
standalone__mha_block_cached__near_ridge_kernel_ns1766:
    v_mov_b32 v64, 0
    v_mov_b32 v65, 0
    v_mov_b32 v66, 0
    v_mov_b32 v67, 0
    v_mov_b32 v68, 0
    v_mov_b32 v69, 0
    v_mov_b32 v70, 0
    v_mov_b32 v71, 0
    v_mov_b32 v72, 0
    v_mov_b32 v73, 0
    v_mov_b32 v74, 0
    v_mov_b32 v75, 0
    v_mov_b32 v76, 0
    v_mov_b32 v77, 0
    v_mov_b32 v78, 0
    v_mov_b32 v79, 0
    v_mov_b32 v80, 0
    v_mov_b32 v81, 0
    v_mov_b32 v82, 0
    v_mov_b32 v83, 0
    v_mov_b32 v84, 0
    v_mov_b32 v85, 0
    v_mov_b32 v86, 0
    v_mov_b32 v87, 0
    v_mov_b32 v88, 0
    v_mov_b32 v89, 0
    v_mov_b32 v90, 0
    v_mov_b32 v91, 0
    v_mov_b32 v92, 0
    v_mov_b32 v93, 0
    v_mov_b32 v94, 0
    v_mov_b32 v95, 0
    v_mov_b32 v96, 0
    v_mov_b32 v97, 0
    v_mov_b32 v98, 0
    v_mov_b32 v99, 0
    v_mov_b32 v100, 0
    v_mov_b32 v101, 0
    v_mov_b32 v102, 0
    v_mov_b32 v103, 0
    v_mov_b32 v104, 0
    v_mov_b32 v105, 0
    v_mov_b32 v106, 0
    v_mov_b32 v107, 0
    v_mov_b32 v108, 0
    v_mov_b32 v109, 0
    v_mov_b32 v110, 0
    v_mov_b32 v111, 0
    v_mov_b32 v112, 0
    v_mov_b32 v113, 0
    v_mov_b32 v114, 0
    v_mov_b32 v115, 0
    v_mov_b32 v116, 0
    v_mov_b32 v117, 0
    v_mov_b32 v118, 0
    v_mov_b32 v119, 0
    v_mov_b32 v120, 0
    v_mov_b32 v121, 0
    v_mov_b32 v122, 0
    v_mov_b32 v123, 0
    v_mov_b32 v124, 0
    v_mov_b32 v125, 0
    v_mov_b32 v126, 0
    v_mov_b32 v127, 0
    v_mov_b32 v128, 0
    v_mov_b32 v129, 0
    v_mov_b32 v130, 0
    v_mov_b32 v131, 0
    v_mov_b32 v132, 0
    v_mov_b32 v133, 0
    v_mov_b32 v134, 0
    v_mov_b32 v135, 0
    v_mov_b32 v136, 0
    v_mov_b32 v137, 0
    v_mov_b32 v138, 0
    v_mov_b32 v139, 0
    v_mov_b32 v140, 0
    v_mov_b32 v141, 0
    v_mov_b32 v142, 0
    v_mov_b32 v143, 0
    s_mov_b32 m0, s32
    s_nop 0
    buffer_load_dwordx4 v245, s[8:11], s31 offen nt lds
    buffer_load_dwordx4 v246, s[8:11], s31 offen offset:1024 nt lds
    buffer_load_dwordx4 v247, s[8:11], s31 offen offset:2048 nt lds
    buffer_load_dwordx4 v248, s[8:11], s31 offen offset:3072 nt lds
    s_add_u32 m0, s32, 16384
    s_nop 0
    buffer_load_dwordx4 v249, s[12:15], s31 offen nt lds
    buffer_load_dwordx4 v249, s[12:15], s31 offen offset:1024 nt lds
    buffer_load_dwordx4 v249, s[12:15], s31 offen offset:2048 nt lds
    buffer_load_dwordx4 v249, s[12:15], s31 offen offset:3072 nt lds
    s_add_u32 s31, s31, 16384
    s_add_u32 s34, s34, 1
    s_cmp_eq_u32 s34, 16
    s_cselect_b32 s33, 0x3c0000, 0
    s_add_u32 s31, s31, s33
    s_cmp_ge_u32 s34, 32
    s_cselect_b32 s31, 0x8000000, s31
    s_add_u32 s32, s32, 32768
    s_cmp_ge_u32 s32, 163840
    s_cselect_b32 s33, 98304, 0
    s_sub_u32 s32, s32, s33
    s_waitcnt vmcnt(8)
    s_mov_b32 s47, 19
standalone__mha_block_cached__near_ridge_kernel_Ploop:
    s_barrier
    s_mov_b32 m0, s32
    s_nop 0
    buffer_load_dwordx4 v245, s[8:11], s31 offen nt lds
    buffer_load_dwordx4 v246, s[8:11], s31 offen offset:1024 nt lds
    buffer_load_dwordx4 v247, s[8:11], s31 offen offset:2048 nt lds
    buffer_load_dwordx4 v248, s[8:11], s31 offen offset:3072 nt lds
    s_add_u32 m0, s32, 16384
    s_nop 0
    buffer_load_dwordx4 v249, s[12:15], s31 offen nt lds
    buffer_load_dwordx4 v249, s[12:15], s31 offen offset:1024 nt lds
    buffer_load_dwordx4 v249, s[12:15], s31 offen offset:2048 nt lds
    buffer_load_dwordx4 v249, s[12:15], s31 offen offset:3072 nt lds
    s_add_u32 s31, s31, 16384
    s_add_u32 s34, s34, 1
    s_cmp_eq_u32 s34, 16
    s_cselect_b32 s33, 0x3c0000, 0
    s_add_u32 s31, s31, s33
    s_cmp_ge_u32 s34, 32
    s_cselect_b32 s31, 0x8000000, s31
    s_add_u32 s32, s32, 32768
    s_cmp_ge_u32 s32, 163840
    s_cselect_b32 s33, 98304, 0
    s_sub_u32 s32, s32, s33
    s_waitcnt vmcnt(8)
    s_add_u32 s47, s47, 1
    s_cmp_lt_u32 s47, 30
    s_cbranch_scc1 standalone__mha_block_cached__near_ridge_kernel_Ploop
    s_barrier
    ds_write_b32 v228, v228 offset:4
    ds_write_b32 v228, v228 offset:8
    ds_write_b32 v228, v228 offset:12
    s_waitcnt vmcnt(0) lgkmcnt(0)
    s_barrier
    s_add_u32 s3, s3, 4
    s_branch standalone__mha_block_cached__near_ridge_kernel_Tail
standalone__mha_block_cached__near_ridge_kernel_A:
    s_nop 4
    s_mov_b32 s24, s44
    s_and_b32 s25, s45, 0xffff
    s_mov_b32 s26, 0x1000000
    s_mov_b32 s27, 0x20000
    v_and_b32 v5, 15, v0
    v_and_b32 v4, 31, v0
    v_lshrrev_b32 v6, 5, v0
    v_xor_b32 v7, v6, v5
    v_lshlrev_b32 v7, 4, v7
    v_lshl_add_u32 v7, v4, 8, v7
    v_add_u32 v7, 65536, v7
    v_xor_b32 v240, 0, v7
    v_xor_b32 v241, 32, v7
    v_xor_b32 v242, 64, v7
    v_xor_b32 v243, 96, v7
    v_xor_b32 v244, 128, v7
    v_xor_b32 v245, 160, v7
    v_xor_b32 v246, 192, v7
    v_xor_b32 v247, 224, v7
    v_bfe_u32 v8, v0, 2, 2
    v_lshl_add_u32 v9, v6, 2, v8
    v_lshlrev_b32 v9, 8, v9
    v_bfe_u32 v10, v0, 4, 1
    v_lshl_add_u32 v9, v10, 5, v9
    v_and_b32 v10, 3, v0
    v_lshl_add_u32 v9, v10, 3, v9
    v_add_u32 v9, 81920, v9
    v_xor_b32 v10, 0, v8
    v_lshl_add_u32 v248, v10, 6, v9
    v_xor_b32 v10, 1, v8
    v_lshl_add_u32 v249, v10, 6, v9
    v_xor_b32 v10, 2, v8
    v_lshl_add_u32 v250, v10, 6, v9
    v_xor_b32 v10, 3, v8
    v_lshl_add_u32 v251, v10, 6, v9
    v_bfe_u32 v10, v0, 4, 1
    v_lshlrev_b32 v10, 17, v10
    v_lshl_add_u32 v10, v5, 4, v10
    v_lshl_add_u32 v15, v6, 8, v10
    s_lshl_b32 s34, s7, 3
    s_lshl_b32 s33, s3, 1
    s_add_u32 s34, s34, s33
    s_lshl_b32 s34, s34, 7
    s_lshl_b32 s33, s6, 2
    s_add_u32 s34, s34, s33
    s_add_u32 s34, s34, 64
    s_lshl_b32 s34, s34, 10
    s_lshl_b32 s33, s3, 13
    v_lshlrev_b32 v14, 4, v0
    v_add_u32 v14, s33, v14
    v_add_u32 v1, 32768, v14
    s_mov_b32 s49, -65536
    s_mov_b32 s50, 32768
    s_mov_b32 s35, 0
    s_mov_b32 s46, 0
    s_mov_b32 s16, s42
    s_and_b32 s17, s43, 0xffff
    s_mov_b32 s18, 0x500000
    s_mov_b32 s19, 0x20000
    v_lshrrev_b32 v4, 4, v0
    v_and_b32 v5, 15, v0
    v_lshlrev_b32 v6, 2, v4
    v_xor_b32 v6, v6, v5
    v_lshlrev_b32 v6, 4, v6
    v_lshl_add_u32 v152, v4, 13, v6
    s_lshl_b32 s28, s3, 17
    s_lshl_b32 s33, s6, 8
    s_add_u32 s28, s28, s33
    s_lshl_b32 s30, s3, 12
    s_add_u32 m0, s30, 0
    s_add_u32 s33, s28, 0
    buffer_load_dwordx4 v152, s[16:19], s33 offen lds
    s_add_u32 m0, s30, 1024
    s_add_u32 s33, s28, 32768
    buffer_load_dwordx4 v152, s[16:19], s33 offen lds
    s_add_u32 m0, s30, 2048
    s_add_u32 s33, s28, 65536
    buffer_load_dwordx4 v152, s[16:19], s33 offen lds
    s_add_u32 m0, s30, 3072
    s_add_u32 s33, s28, 98304
    buffer_load_dwordx4 v152, s[16:19], s33 offen lds
    v_lshrrev_b32 v6, 5, v0
    v_bfe_u32 v8, v0, 2, 2
    v_lshl_add_u32 v9, v6, 3, v8
    v_lshlrev_b32 v9, 8, v9
    v_bfe_u32 v10, v0, 4, 1
    v_lshl_add_u32 v9, v10, 5, v9
    v_and_b32 v10, 1, v0
    v_lshl_add_u32 v9, v10, 4, v9
    v_bfe_u32 v10, v0, 1, 1
    v_lshl_add_u32 v9, v10, 3, v9
    v_add_u32 v9, 0, v9
    v_xor_b32 v10, 0, v8
    v_lshl_add_u32 v128, v10, 6, v9
    v_add_u32 v132, 49152, v128
    v_add_u32 v136, 98304, v128
    v_xor_b32 v10, 1, v8
    v_lshl_add_u32 v129, v10, 6, v9
    v_add_u32 v133, 49152, v129
    v_add_u32 v137, 98304, v129
    v_xor_b32 v10, 2, v8
    v_lshl_add_u32 v130, v10, 6, v9
    v_add_u32 v134, 49152, v130
    v_add_u32 v138, 98304, v130
    v_xor_b32 v10, 3, v8
    v_lshl_add_u32 v131, v10, 6, v9
    v_add_u32 v135, 49152, v131
    v_add_u32 v139, 98304, v131
    v_and_b32 v8, 31, v0
    v_bfe_u32 v9, v0, 1, 3
    v_xor_b32 v9, v9, v6
    v_lshlrev_b32 v9, 4, v9
    v_lshl_add_u32 v9, v8, 7, v9
    s_add_u32 s33, s30, 32768
    v_add_u32 v9, s33, v9
    v_xor_b32 v140, 0, v9
    v_add_u32 v144, 49152, v140
    v_add_u32 v148, 98304, v140
    v_xor_b32 v141, 32, v9
    v_add_u32 v145, 49152, v141
    v_add_u32 v149, 98304, v141
    v_xor_b32 v142, 64, v9
    v_add_u32 v146, 49152, v142
    v_add_u32 v150, 98304, v142
    v_xor_b32 v143, 96, v9
    v_add_u32 v147, 49152, v143
    v_add_u32 v151, 98304, v143
    s_add_u32 m0, s30, 49152
    s_add_u32 s33, s28, 524288
    buffer_load_dwordx4 v152, s[16:19], s33 offen lds
    s_add_u32 m0, s30, 50176
    s_add_u32 s33, s28, 557056
    buffer_load_dwordx4 v152, s[16:19], s33 offen lds
    s_add_u32 m0, s30, 51200
    s_add_u32 s33, s28, 589824
    buffer_load_dwordx4 v152, s[16:19], s33 offen lds
    s_add_u32 m0, s30, 52224
    s_add_u32 s33, s28, 622592
    buffer_load_dwordx4 v152, s[16:19], s33 offen lds
    s_add_u32 m0, s30, 98304
    s_add_u32 s33, s28, 1048576
    buffer_load_dwordx4 v152, s[16:19], s33 offen lds
    s_add_u32 m0, s30, 99328
    s_add_u32 s33, s28, 1081344
    buffer_load_dwordx4 v152, s[16:19], s33 offen lds
    s_add_u32 m0, s30, 100352
    s_add_u32 s33, s28, 1114112
    buffer_load_dwordx4 v152, s[16:19], s33 offen lds
    s_add_u32 m0, s30, 101376
    s_add_u32 s33, s28, 1146880
    buffer_load_dwordx4 v152, s[16:19], s33 offen lds
    s_mov_b32 s48, 0x3e0293ee
    s_waitcnt vmcnt(8)
    s_barrier
    ds_read_b128 v[208:211], v140
    ds_read_b64_tr_b16 v[176:177], v128
    ds_read_b64_tr_b16 v[178:179], v128 offset:1024
    ds_read_b64_tr_b16 v[180:181], v129
    ds_read_b64_tr_b16 v[182:183], v129 offset:1024
    ds_read_b64_tr_b16 v[184:185], v130
    ds_read_b64_tr_b16 v[186:187], v130 offset:1024
    ds_read_b64_tr_b16 v[188:189], v131
    ds_read_b64_tr_b16 v[190:191], v131 offset:1024
    ds_read_b128 v[212:215], v141
    ds_read_b128 v[216:219], v142
    ds_read_b128 v[220:223], v143
    s_waitcnt lgkmcnt(3)
    ds_read_b64_tr_b16 v[192:193], v128 offset:4096
    ds_read_b64_tr_b16 v[194:195], v128 offset:5120
    ds_read_b64_tr_b16 v[196:197], v129 offset:4096
    ds_read_b64_tr_b16 v[198:199], v129 offset:5120
    ds_read_b64_tr_b16 v[200:201], v130 offset:4096
    ds_read_b64_tr_b16 v[202:203], v130 offset:5120
    ds_read_b64_tr_b16 v[204:205], v131 offset:4096
    ds_read_b64_tr_b16 v[206:207], v131 offset:5120
    v_mfma_f32_32x32x16_bf16 v[64:79], v[176:179], v[208:211], 0
    v_mfma_f32_32x32x16_bf16 v[80:95], v[180:183], v[208:211], 0
    v_mfma_f32_32x32x16_bf16 v[96:111], v[184:187], v[208:211], 0
    v_mfma_f32_32x32x16_bf16 v[112:127], v[188:191], v[208:211], 0
    ds_read_b64_tr_b16 v[176:177], v128 offset:8192
    ds_read_b64_tr_b16 v[178:179], v128 offset:9216
    ds_read_b64_tr_b16 v[180:181], v129 offset:8192
    ds_read_b64_tr_b16 v[182:183], v129 offset:9216
    s_waitcnt lgkmcnt(14)
    ds_read_b64_tr_b16 v[184:185], v130 offset:8192
    s_waitcnt lgkmcnt(14)
    ds_read_b64_tr_b16 v[186:187], v130 offset:9216
    s_waitcnt lgkmcnt(14)
    ds_read_b64_tr_b16 v[188:189], v131 offset:8192
    s_waitcnt lgkmcnt(14)
    ds_read_b64_tr_b16 v[190:191], v131 offset:9216
    s_waitcnt lgkmcnt(8)
    v_mfma_f32_32x32x16_bf16 v[64:79], v[192:195], v[212:215], v[64:79]
    v_mfma_f32_32x32x16_bf16 v[80:95], v[196:199], v[212:215], v[80:95]
    v_mfma_f32_32x32x16_bf16 v[96:111], v[200:203], v[212:215], v[96:111]
    v_mfma_f32_32x32x16_bf16 v[112:127], v[204:207], v[212:215], v[112:127]
    ds_read_b64_tr_b16 v[192:193], v128 offset:12288
    ds_read_b64_tr_b16 v[194:195], v128 offset:13312
    ds_read_b64_tr_b16 v[196:197], v129 offset:12288
    ds_read_b64_tr_b16 v[198:199], v129 offset:13312
    ds_read_b64_tr_b16 v[200:201], v130 offset:12288
    ds_read_b64_tr_b16 v[202:203], v130 offset:13312
    ds_read_b64_tr_b16 v[204:205], v131 offset:12288
    s_waitcnt lgkmcnt(14)
    ds_read_b64_tr_b16 v[206:207], v131 offset:13312
    s_waitcnt lgkmcnt(8)
    v_mfma_f32_32x32x16_bf16 v[64:79], v[176:179], v[216:219], v[64:79]
    v_mfma_f32_32x32x16_bf16 v[80:95], v[180:183], v[216:219], v[80:95]
    v_mfma_f32_32x32x16_bf16 v[96:111], v[184:187], v[216:219], v[96:111]
    v_mfma_f32_32x32x16_bf16 v[112:127], v[188:191], v[216:219], v[112:127]
    s_waitcnt lgkmcnt(0)
    s_waitcnt vmcnt(4)
    s_barrier
    ds_read_b128 v[208:211], v144
    ds_read_b64_tr_b16 v[176:177], v132
    ds_read_b64_tr_b16 v[178:179], v132 offset:1024
    ds_read_b64_tr_b16 v[180:181], v133
    ds_read_b64_tr_b16 v[182:183], v133 offset:1024
    ds_read_b64_tr_b16 v[184:185], v134
    ds_read_b64_tr_b16 v[186:187], v134 offset:1024
    ds_read_b64_tr_b16 v[188:189], v135
    ds_read_b64_tr_b16 v[190:191], v135 offset:1024
    v_mfma_f32_32x32x16_bf16 v[64:79], v[192:195], v[220:223], v[64:79]
    s_add_u32 m0, s30, 0
    s_add_u32 s33, s28, 1572864
    buffer_load_dwordx4 v152, s[16:19], s33 offen lds
    v_mfma_f32_32x32x16_bf16 v[80:95], v[196:199], v[220:223], v[80:95]
    v_mfma_f32_32x32x16_bf16 v[96:111], v[200:203], v[220:223], v[96:111]
    v_mfma_f32_32x32x16_bf16 v[112:127], v[204:207], v[220:223], v[112:127]
    ds_read_b128 v[212:215], v145
    ds_read_b128 v[216:219], v146
    ds_read_b128 v[220:223], v147
    s_waitcnt lgkmcnt(3)
    ds_read_b64_tr_b16 v[192:193], v132 offset:4096
    ds_read_b64_tr_b16 v[194:195], v132 offset:5120
    ds_read_b64_tr_b16 v[196:197], v133 offset:4096
    ds_read_b64_tr_b16 v[198:199], v133 offset:5120
    ds_read_b64_tr_b16 v[200:201], v134 offset:4096
    ds_read_b64_tr_b16 v[202:203], v134 offset:5120
    ds_read_b64_tr_b16 v[204:205], v135 offset:4096
    ds_read_b64_tr_b16 v[206:207], v135 offset:5120
    v_mfma_f32_32x32x16_bf16 v[64:79], v[176:179], v[208:211], v[64:79]
    s_add_u32 m0, s30, 1024
    s_add_u32 s33, s28, 1605632
    buffer_load_dwordx4 v152, s[16:19], s33 offen lds
    v_mfma_f32_32x32x16_bf16 v[80:95], v[180:183], v[208:211], v[80:95]
    v_mfma_f32_32x32x16_bf16 v[96:111], v[184:187], v[208:211], v[96:111]
    v_mfma_f32_32x32x16_bf16 v[112:127], v[188:191], v[208:211], v[112:127]
    ds_read_b64_tr_b16 v[176:177], v132 offset:8192
    ds_read_b64_tr_b16 v[178:179], v132 offset:9216
    ds_read_b64_tr_b16 v[180:181], v133 offset:8192
    ds_read_b64_tr_b16 v[182:183], v133 offset:9216
    s_waitcnt lgkmcnt(14)
    ds_read_b64_tr_b16 v[184:185], v134 offset:8192
    s_waitcnt lgkmcnt(14)
    ds_read_b64_tr_b16 v[186:187], v134 offset:9216
    s_waitcnt lgkmcnt(14)
    ds_read_b64_tr_b16 v[188:189], v135 offset:8192
    s_waitcnt lgkmcnt(14)
    ds_read_b64_tr_b16 v[190:191], v135 offset:9216
    s_waitcnt lgkmcnt(8)
    v_mfma_f32_32x32x16_bf16 v[64:79], v[192:195], v[212:215], v[64:79]
    s_add_u32 m0, s30, 2048
    s_add_u32 s33, s28, 1638400
    buffer_load_dwordx4 v152, s[16:19], s33 offen lds
    v_mfma_f32_32x32x16_bf16 v[80:95], v[196:199], v[212:215], v[80:95]
    v_mfma_f32_32x32x16_bf16 v[96:111], v[200:203], v[212:215], v[96:111]
    v_mfma_f32_32x32x16_bf16 v[112:127], v[204:207], v[212:215], v[112:127]
    ds_read_b64_tr_b16 v[192:193], v132 offset:12288
    ds_read_b64_tr_b16 v[194:195], v132 offset:13312
    ds_read_b64_tr_b16 v[196:197], v133 offset:12288
    ds_read_b64_tr_b16 v[198:199], v133 offset:13312
    ds_read_b64_tr_b16 v[200:201], v134 offset:12288
    ds_read_b64_tr_b16 v[202:203], v134 offset:13312
    ds_read_b64_tr_b16 v[204:205], v135 offset:12288
    s_waitcnt lgkmcnt(14)
    ds_read_b64_tr_b16 v[206:207], v135 offset:13312
    s_waitcnt lgkmcnt(8)
    v_mfma_f32_32x32x16_bf16 v[64:79], v[176:179], v[216:219], v[64:79]
    s_add_u32 m0, s30, 3072
    s_add_u32 s33, s28, 1671168
    buffer_load_dwordx4 v152, s[16:19], s33 offen lds
    v_mfma_f32_32x32x16_bf16 v[80:95], v[180:183], v[216:219], v[80:95]
    v_mfma_f32_32x32x16_bf16 v[96:111], v[184:187], v[216:219], v[96:111]
    v_mfma_f32_32x32x16_bf16 v[112:127], v[188:191], v[216:219], v[112:127]
    s_waitcnt lgkmcnt(0)
    s_waitcnt vmcnt(4)
    s_barrier
    ds_read_b128 v[208:211], v148
    ds_read_b64_tr_b16 v[176:177], v136
    ds_read_b64_tr_b16 v[178:179], v136 offset:1024
    ds_read_b64_tr_b16 v[180:181], v137
    ds_read_b64_tr_b16 v[182:183], v137 offset:1024
    ds_read_b64_tr_b16 v[184:185], v138
    ds_read_b64_tr_b16 v[186:187], v138 offset:1024
    ds_read_b64_tr_b16 v[188:189], v139
    ds_read_b64_tr_b16 v[190:191], v139 offset:1024
    v_mfma_f32_32x32x16_bf16 v[64:79], v[192:195], v[220:223], v[64:79]
    s_add_u32 m0, s30, 49152
    s_add_u32 s33, s28, 2097152
    buffer_load_dwordx4 v152, s[16:19], s33 offen lds
    v_mfma_f32_32x32x16_bf16 v[80:95], v[196:199], v[220:223], v[80:95]
    v_mfma_f32_32x32x16_bf16 v[96:111], v[200:203], v[220:223], v[96:111]
    v_mfma_f32_32x32x16_bf16 v[112:127], v[204:207], v[220:223], v[112:127]
    ds_read_b128 v[212:215], v149
    ds_read_b128 v[216:219], v150
    ds_read_b128 v[220:223], v151
    s_waitcnt lgkmcnt(3)
    ds_read_b64_tr_b16 v[192:193], v136 offset:4096
    ds_read_b64_tr_b16 v[194:195], v136 offset:5120
    ds_read_b64_tr_b16 v[196:197], v137 offset:4096
    ds_read_b64_tr_b16 v[198:199], v137 offset:5120
    ds_read_b64_tr_b16 v[200:201], v138 offset:4096
    ds_read_b64_tr_b16 v[202:203], v138 offset:5120
    ds_read_b64_tr_b16 v[204:205], v139 offset:4096
    ds_read_b64_tr_b16 v[206:207], v139 offset:5120
    v_mfma_f32_32x32x16_bf16 v[64:79], v[176:179], v[208:211], v[64:79]
    s_add_u32 m0, s30, 50176
    s_add_u32 s33, s28, 2129920
    buffer_load_dwordx4 v152, s[16:19], s33 offen lds
    v_mfma_f32_32x32x16_bf16 v[80:95], v[180:183], v[208:211], v[80:95]
    v_mfma_f32_32x32x16_bf16 v[96:111], v[184:187], v[208:211], v[96:111]
    v_mfma_f32_32x32x16_bf16 v[112:127], v[188:191], v[208:211], v[112:127]
    ds_read_b64_tr_b16 v[176:177], v136 offset:8192
    ds_read_b64_tr_b16 v[178:179], v136 offset:9216
    ds_read_b64_tr_b16 v[180:181], v137 offset:8192
    ds_read_b64_tr_b16 v[182:183], v137 offset:9216
    s_waitcnt lgkmcnt(14)
    ds_read_b64_tr_b16 v[184:185], v138 offset:8192
    s_waitcnt lgkmcnt(14)
    ds_read_b64_tr_b16 v[186:187], v138 offset:9216
    s_waitcnt lgkmcnt(14)
    ds_read_b64_tr_b16 v[188:189], v139 offset:8192
    s_waitcnt lgkmcnt(14)
    ds_read_b64_tr_b16 v[190:191], v139 offset:9216
    s_waitcnt lgkmcnt(8)
    v_mfma_f32_32x32x16_bf16 v[64:79], v[192:195], v[212:215], v[64:79]
    s_add_u32 m0, s30, 51200
    s_add_u32 s33, s28, 2162688
    buffer_load_dwordx4 v152, s[16:19], s33 offen lds
    v_mfma_f32_32x32x16_bf16 v[80:95], v[196:199], v[212:215], v[80:95]
    v_mfma_f32_32x32x16_bf16 v[96:111], v[200:203], v[212:215], v[96:111]
    v_mfma_f32_32x32x16_bf16 v[112:127], v[204:207], v[212:215], v[112:127]
    ds_read_b64_tr_b16 v[192:193], v136 offset:12288
    ds_read_b64_tr_b16 v[194:195], v136 offset:13312
    ds_read_b64_tr_b16 v[196:197], v137 offset:12288
    ds_read_b64_tr_b16 v[198:199], v137 offset:13312
    ds_read_b64_tr_b16 v[200:201], v138 offset:12288
    ds_read_b64_tr_b16 v[202:203], v138 offset:13312
    ds_read_b64_tr_b16 v[204:205], v139 offset:12288
    s_waitcnt lgkmcnt(14)
    ds_read_b64_tr_b16 v[206:207], v139 offset:13312
    s_waitcnt lgkmcnt(8)
    v_mfma_f32_32x32x16_bf16 v[64:79], v[176:179], v[216:219], v[64:79]
    s_add_u32 m0, s30, 52224
    s_add_u32 s33, s28, 2195456
    buffer_load_dwordx4 v152, s[16:19], s33 offen lds
    v_mfma_f32_32x32x16_bf16 v[80:95], v[180:183], v[216:219], v[80:95]
    v_mfma_f32_32x32x16_bf16 v[96:111], v[184:187], v[216:219], v[96:111]
    v_mfma_f32_32x32x16_bf16 v[112:127], v[188:191], v[216:219], v[112:127]
    s_waitcnt lgkmcnt(0)
    s_waitcnt vmcnt(4)
    s_barrier
    ds_read_b128 v[208:211], v140
    ds_read_b64_tr_b16 v[176:177], v128
    ds_read_b64_tr_b16 v[178:179], v128 offset:1024
    ds_read_b64_tr_b16 v[180:181], v129
    ds_read_b64_tr_b16 v[182:183], v129 offset:1024
    ds_read_b64_tr_b16 v[184:185], v130
    ds_read_b64_tr_b16 v[186:187], v130 offset:1024
    ds_read_b64_tr_b16 v[188:189], v131
    ds_read_b64_tr_b16 v[190:191], v131 offset:1024
    v_mfma_f32_32x32x16_bf16 v[64:79], v[192:195], v[220:223], v[64:79]
    s_add_u32 m0, s30, 98304
    s_add_u32 s33, s28, 2621440
    buffer_load_dwordx4 v152, s[16:19], s33 offen lds
    v_mfma_f32_32x32x16_bf16 v[80:95], v[196:199], v[220:223], v[80:95]
    v_mfma_f32_32x32x16_bf16 v[96:111], v[200:203], v[220:223], v[96:111]
    v_mfma_f32_32x32x16_bf16 v[112:127], v[204:207], v[220:223], v[112:127]
    ds_read_b128 v[212:215], v141
    ds_read_b128 v[216:219], v142
    ds_read_b128 v[220:223], v143
    s_waitcnt lgkmcnt(3)
    ds_read_b64_tr_b16 v[192:193], v128 offset:4096
    ds_read_b64_tr_b16 v[194:195], v128 offset:5120
    ds_read_b64_tr_b16 v[196:197], v129 offset:4096
    ds_read_b64_tr_b16 v[198:199], v129 offset:5120
    ds_read_b64_tr_b16 v[200:201], v130 offset:4096
    ds_read_b64_tr_b16 v[202:203], v130 offset:5120
    ds_read_b64_tr_b16 v[204:205], v131 offset:4096
    ds_read_b64_tr_b16 v[206:207], v131 offset:5120
    v_mfma_f32_32x32x16_bf16 v[64:79], v[176:179], v[208:211], v[64:79]
    s_add_u32 m0, s30, 99328
    s_add_u32 s33, s28, 2654208
    buffer_load_dwordx4 v152, s[16:19], s33 offen lds
    v_mfma_f32_32x32x16_bf16 v[80:95], v[180:183], v[208:211], v[80:95]
    v_mfma_f32_32x32x16_bf16 v[96:111], v[184:187], v[208:211], v[96:111]
    v_mfma_f32_32x32x16_bf16 v[112:127], v[188:191], v[208:211], v[112:127]
    ds_read_b64_tr_b16 v[176:177], v128 offset:8192
    ds_read_b64_tr_b16 v[178:179], v128 offset:9216
    ds_read_b64_tr_b16 v[180:181], v129 offset:8192
    ds_read_b64_tr_b16 v[182:183], v129 offset:9216
    s_waitcnt lgkmcnt(14)
    ds_read_b64_tr_b16 v[184:185], v130 offset:8192
    s_waitcnt lgkmcnt(14)
    ds_read_b64_tr_b16 v[186:187], v130 offset:9216
    s_waitcnt lgkmcnt(14)
    ds_read_b64_tr_b16 v[188:189], v131 offset:8192
    s_waitcnt lgkmcnt(14)
    ds_read_b64_tr_b16 v[190:191], v131 offset:9216
    s_waitcnt lgkmcnt(8)
    v_mfma_f32_32x32x16_bf16 v[64:79], v[192:195], v[212:215], v[64:79]
    s_add_u32 m0, s30, 100352
    s_add_u32 s33, s28, 2686976
    buffer_load_dwordx4 v152, s[16:19], s33 offen lds
    v_mfma_f32_32x32x16_bf16 v[80:95], v[196:199], v[212:215], v[80:95]
    v_mfma_f32_32x32x16_bf16 v[96:111], v[200:203], v[212:215], v[96:111]
    v_mfma_f32_32x32x16_bf16 v[112:127], v[204:207], v[212:215], v[112:127]
    ds_read_b64_tr_b16 v[192:193], v128 offset:12288
    ds_read_b64_tr_b16 v[194:195], v128 offset:13312
    ds_read_b64_tr_b16 v[196:197], v129 offset:12288
    ds_read_b64_tr_b16 v[198:199], v129 offset:13312
    ds_read_b64_tr_b16 v[200:201], v130 offset:12288
    ds_read_b64_tr_b16 v[202:203], v130 offset:13312
    ds_read_b64_tr_b16 v[204:205], v131 offset:12288
    s_waitcnt lgkmcnt(14)
    ds_read_b64_tr_b16 v[206:207], v131 offset:13312
    s_waitcnt lgkmcnt(8)
    v_mfma_f32_32x32x16_bf16 v[64:79], v[176:179], v[216:219], v[64:79]
    s_add_u32 m0, s30, 101376
    s_add_u32 s33, s28, 2719744
    buffer_load_dwordx4 v152, s[16:19], s33 offen lds
    v_mfma_f32_32x32x16_bf16 v[80:95], v[180:183], v[216:219], v[80:95]
    v_mfma_f32_32x32x16_bf16 v[96:111], v[184:187], v[216:219], v[96:111]
    v_mfma_f32_32x32x16_bf16 v[112:127], v[188:191], v[216:219], v[112:127]
    s_waitcnt lgkmcnt(0)
    s_waitcnt vmcnt(4)
    s_barrier
    ds_read_b128 v[208:211], v144
    ds_read_b64_tr_b16 v[176:177], v132
    ds_read_b64_tr_b16 v[178:179], v132 offset:1024
    ds_read_b64_tr_b16 v[180:181], v133
    ds_read_b64_tr_b16 v[182:183], v133 offset:1024
    ds_read_b64_tr_b16 v[184:185], v134
    ds_read_b64_tr_b16 v[186:187], v134 offset:1024
    ds_read_b64_tr_b16 v[188:189], v135
    ds_read_b64_tr_b16 v[190:191], v135 offset:1024
    v_mfma_f32_32x32x16_bf16 v[64:79], v[192:195], v[220:223], v[64:79]
    s_add_u32 m0, s30, 0
    s_add_u32 s33, s28, 3145728
    buffer_load_dwordx4 v152, s[16:19], s33 offen lds
    v_mfma_f32_32x32x16_bf16 v[80:95], v[196:199], v[220:223], v[80:95]
    v_mfma_f32_32x32x16_bf16 v[96:111], v[200:203], v[220:223], v[96:111]
    v_mfma_f32_32x32x16_bf16 v[112:127], v[204:207], v[220:223], v[112:127]
    ds_read_b128 v[212:215], v145
    ds_read_b128 v[216:219], v146
    ds_read_b128 v[220:223], v147
    s_waitcnt lgkmcnt(3)
    ds_read_b64_tr_b16 v[192:193], v132 offset:4096
    ds_read_b64_tr_b16 v[194:195], v132 offset:5120
    ds_read_b64_tr_b16 v[196:197], v133 offset:4096
    ds_read_b64_tr_b16 v[198:199], v133 offset:5120
    ds_read_b64_tr_b16 v[200:201], v134 offset:4096
    ds_read_b64_tr_b16 v[202:203], v134 offset:5120
    ds_read_b64_tr_b16 v[204:205], v135 offset:4096
    ds_read_b64_tr_b16 v[206:207], v135 offset:5120
    v_mfma_f32_32x32x16_bf16 v[64:79], v[176:179], v[208:211], v[64:79]
    s_add_u32 m0, s30, 1024
    s_add_u32 s33, s28, 3178496
    buffer_load_dwordx4 v152, s[16:19], s33 offen lds
    v_mfma_f32_32x32x16_bf16 v[80:95], v[180:183], v[208:211], v[80:95]
    v_mfma_f32_32x32x16_bf16 v[96:111], v[184:187], v[208:211], v[96:111]
    v_mfma_f32_32x32x16_bf16 v[112:127], v[188:191], v[208:211], v[112:127]
    ds_read_b64_tr_b16 v[176:177], v132 offset:8192
    ds_read_b64_tr_b16 v[178:179], v132 offset:9216
    ds_read_b64_tr_b16 v[180:181], v133 offset:8192
    ds_read_b64_tr_b16 v[182:183], v133 offset:9216
    s_waitcnt lgkmcnt(14)
    ds_read_b64_tr_b16 v[184:185], v134 offset:8192
    s_waitcnt lgkmcnt(14)
    ds_read_b64_tr_b16 v[186:187], v134 offset:9216
    s_waitcnt lgkmcnt(14)
    ds_read_b64_tr_b16 v[188:189], v135 offset:8192
    s_waitcnt lgkmcnt(14)
    ds_read_b64_tr_b16 v[190:191], v135 offset:9216
    s_waitcnt lgkmcnt(8)
    v_mfma_f32_32x32x16_bf16 v[64:79], v[192:195], v[212:215], v[64:79]
    s_add_u32 m0, s30, 2048
    s_add_u32 s33, s28, 3211264
    buffer_load_dwordx4 v152, s[16:19], s33 offen lds
    v_mfma_f32_32x32x16_bf16 v[80:95], v[196:199], v[212:215], v[80:95]
    v_mfma_f32_32x32x16_bf16 v[96:111], v[200:203], v[212:215], v[96:111]
    v_mfma_f32_32x32x16_bf16 v[112:127], v[204:207], v[212:215], v[112:127]
    ds_read_b64_tr_b16 v[192:193], v132 offset:12288
    ds_read_b64_tr_b16 v[194:195], v132 offset:13312
    ds_read_b64_tr_b16 v[196:197], v133 offset:12288
    ds_read_b64_tr_b16 v[198:199], v133 offset:13312
    ds_read_b64_tr_b16 v[200:201], v134 offset:12288
    ds_read_b64_tr_b16 v[202:203], v134 offset:13312
    ds_read_b64_tr_b16 v[204:205], v135 offset:12288
    s_waitcnt lgkmcnt(14)
    ds_read_b64_tr_b16 v[206:207], v135 offset:13312
    s_waitcnt lgkmcnt(8)
    v_mfma_f32_32x32x16_bf16 v[64:79], v[176:179], v[216:219], v[64:79]
    s_add_u32 m0, s30, 3072
    s_add_u32 s33, s28, 3244032
    buffer_load_dwordx4 v152, s[16:19], s33 offen lds
    v_mfma_f32_32x32x16_bf16 v[80:95], v[180:183], v[216:219], v[80:95]
    v_mfma_f32_32x32x16_bf16 v[96:111], v[184:187], v[216:219], v[96:111]
    v_mfma_f32_32x32x16_bf16 v[112:127], v[188:191], v[216:219], v[112:127]
    s_waitcnt lgkmcnt(0)
    s_waitcnt vmcnt(4)
    s_barrier
    ds_read_b128 v[208:211], v148
    ds_read_b64_tr_b16 v[176:177], v136
    ds_read_b64_tr_b16 v[178:179], v136 offset:1024
    ds_read_b64_tr_b16 v[180:181], v137
    ds_read_b64_tr_b16 v[182:183], v137 offset:1024
    ds_read_b64_tr_b16 v[184:185], v138
    ds_read_b64_tr_b16 v[186:187], v138 offset:1024
    ds_read_b64_tr_b16 v[188:189], v139
    ds_read_b64_tr_b16 v[190:191], v139 offset:1024
    v_mfma_f32_32x32x16_bf16 v[64:79], v[192:195], v[220:223], v[64:79]
    s_add_u32 m0, s30, 49152
    s_add_u32 s33, s28, 3670016
    buffer_load_dwordx4 v152, s[16:19], s33 offen lds
    v_mfma_f32_32x32x16_bf16 v[80:95], v[196:199], v[220:223], v[80:95]
    v_mfma_f32_32x32x16_bf16 v[96:111], v[200:203], v[220:223], v[96:111]
    v_mfma_f32_32x32x16_bf16 v[112:127], v[204:207], v[220:223], v[112:127]
    ds_read_b128 v[212:215], v149
    ds_read_b128 v[216:219], v150
    ds_read_b128 v[220:223], v151
    s_waitcnt lgkmcnt(3)
    ds_read_b64_tr_b16 v[192:193], v136 offset:4096
    ds_read_b64_tr_b16 v[194:195], v136 offset:5120
    ds_read_b64_tr_b16 v[196:197], v137 offset:4096
    ds_read_b64_tr_b16 v[198:199], v137 offset:5120
    ds_read_b64_tr_b16 v[200:201], v138 offset:4096
    ds_read_b64_tr_b16 v[202:203], v138 offset:5120
    ds_read_b64_tr_b16 v[204:205], v139 offset:4096
    ds_read_b64_tr_b16 v[206:207], v139 offset:5120
    v_mfma_f32_32x32x16_bf16 v[64:79], v[176:179], v[208:211], v[64:79]
    s_add_u32 m0, s30, 50176
    s_add_u32 s33, s28, 3702784
    buffer_load_dwordx4 v152, s[16:19], s33 offen lds
    v_mfma_f32_32x32x16_bf16 v[80:95], v[180:183], v[208:211], v[80:95]
    v_mfma_f32_32x32x16_bf16 v[96:111], v[184:187], v[208:211], v[96:111]
    v_mfma_f32_32x32x16_bf16 v[112:127], v[188:191], v[208:211], v[112:127]
    ds_read_b64_tr_b16 v[176:177], v136 offset:8192
    ds_read_b64_tr_b16 v[178:179], v136 offset:9216
    ds_read_b64_tr_b16 v[180:181], v137 offset:8192
    ds_read_b64_tr_b16 v[182:183], v137 offset:9216
    s_waitcnt lgkmcnt(14)
    ds_read_b64_tr_b16 v[184:185], v138 offset:8192
    s_waitcnt lgkmcnt(14)
    ds_read_b64_tr_b16 v[186:187], v138 offset:9216
    s_waitcnt lgkmcnt(14)
    ds_read_b64_tr_b16 v[188:189], v139 offset:8192
    s_waitcnt lgkmcnt(14)
    ds_read_b64_tr_b16 v[190:191], v139 offset:9216
    s_waitcnt lgkmcnt(8)
    v_mfma_f32_32x32x16_bf16 v[64:79], v[192:195], v[212:215], v[64:79]
    s_add_u32 m0, s30, 51200
    s_add_u32 s33, s28, 3735552
    buffer_load_dwordx4 v152, s[16:19], s33 offen lds
    v_mfma_f32_32x32x16_bf16 v[80:95], v[196:199], v[212:215], v[80:95]
    v_mfma_f32_32x32x16_bf16 v[96:111], v[200:203], v[212:215], v[96:111]
    v_mfma_f32_32x32x16_bf16 v[112:127], v[204:207], v[212:215], v[112:127]
    ds_read_b64_tr_b16 v[192:193], v136 offset:12288
    ds_read_b64_tr_b16 v[194:195], v136 offset:13312
    ds_read_b64_tr_b16 v[196:197], v137 offset:12288
    ds_read_b64_tr_b16 v[198:199], v137 offset:13312
    ds_read_b64_tr_b16 v[200:201], v138 offset:12288
    ds_read_b64_tr_b16 v[202:203], v138 offset:13312
    ds_read_b64_tr_b16 v[204:205], v139 offset:12288
    s_waitcnt lgkmcnt(14)
    ds_read_b64_tr_b16 v[206:207], v139 offset:13312
    s_waitcnt lgkmcnt(8)
    v_mfma_f32_32x32x16_bf16 v[64:79], v[176:179], v[216:219], v[64:79]
    s_add_u32 m0, s30, 52224
    s_add_u32 s33, s28, 3768320
    buffer_load_dwordx4 v152, s[16:19], s33 offen lds
    v_mfma_f32_32x32x16_bf16 v[80:95], v[180:183], v[216:219], v[80:95]
    v_mfma_f32_32x32x16_bf16 v[96:111], v[184:187], v[216:219], v[96:111]
    v_mfma_f32_32x32x16_bf16 v[112:127], v[188:191], v[216:219], v[112:127]
    s_waitcnt lgkmcnt(0)
    s_waitcnt vmcnt(4)
    s_barrier
    ds_read_b128 v[208:211], v140
    ds_read_b64_tr_b16 v[176:177], v128
    ds_read_b64_tr_b16 v[178:179], v128 offset:1024
    ds_read_b64_tr_b16 v[180:181], v129
    ds_read_b64_tr_b16 v[182:183], v129 offset:1024
    ds_read_b64_tr_b16 v[184:185], v130
    ds_read_b64_tr_b16 v[186:187], v130 offset:1024
    ds_read_b64_tr_b16 v[188:189], v131
    ds_read_b64_tr_b16 v[190:191], v131 offset:1024
    v_mfma_f32_32x32x16_bf16 v[64:79], v[192:195], v[220:223], v[64:79]
    s_add_u32 m0, s30, 98304
    s_add_u32 s33, s28, 4194304
    buffer_load_dwordx4 v152, s[16:19], s33 offen lds
    v_mfma_f32_32x32x16_bf16 v[80:95], v[196:199], v[220:223], v[80:95]
    v_mfma_f32_32x32x16_bf16 v[96:111], v[200:203], v[220:223], v[96:111]
    v_mfma_f32_32x32x16_bf16 v[112:127], v[204:207], v[220:223], v[112:127]
    ds_read_b128 v[212:215], v141
    ds_read_b128 v[216:219], v142
    ds_read_b128 v[220:223], v143
    s_waitcnt lgkmcnt(3)
    ds_read_b64_tr_b16 v[192:193], v128 offset:4096
    ds_read_b64_tr_b16 v[194:195], v128 offset:5120
    ds_read_b64_tr_b16 v[196:197], v129 offset:4096
    ds_read_b64_tr_b16 v[198:199], v129 offset:5120
    ds_read_b64_tr_b16 v[200:201], v130 offset:4096
    ds_read_b64_tr_b16 v[202:203], v130 offset:5120
    ds_read_b64_tr_b16 v[204:205], v131 offset:4096
    ds_read_b64_tr_b16 v[206:207], v131 offset:5120
    v_mfma_f32_32x32x16_bf16 v[64:79], v[176:179], v[208:211], v[64:79]
    s_add_u32 m0, s30, 99328
    s_add_u32 s33, s28, 4227072
    buffer_load_dwordx4 v152, s[16:19], s33 offen lds
    v_mfma_f32_32x32x16_bf16 v[80:95], v[180:183], v[208:211], v[80:95]
    v_mfma_f32_32x32x16_bf16 v[96:111], v[184:187], v[208:211], v[96:111]
    v_mfma_f32_32x32x16_bf16 v[112:127], v[188:191], v[208:211], v[112:127]
    ds_read_b64_tr_b16 v[176:177], v128 offset:8192
    ds_read_b64_tr_b16 v[178:179], v128 offset:9216
    ds_read_b64_tr_b16 v[180:181], v129 offset:8192
    ds_read_b64_tr_b16 v[182:183], v129 offset:9216
    s_waitcnt lgkmcnt(14)
    ds_read_b64_tr_b16 v[184:185], v130 offset:8192
    s_waitcnt lgkmcnt(14)
    ds_read_b64_tr_b16 v[186:187], v130 offset:9216
    s_waitcnt lgkmcnt(14)
    ds_read_b64_tr_b16 v[188:189], v131 offset:8192
    s_waitcnt lgkmcnt(14)
    ds_read_b64_tr_b16 v[190:191], v131 offset:9216
    s_waitcnt lgkmcnt(8)
    v_mfma_f32_32x32x16_bf16 v[64:79], v[192:195], v[212:215], v[64:79]
    s_add_u32 m0, s30, 100352
    s_add_u32 s33, s28, 4259840
    buffer_load_dwordx4 v152, s[16:19], s33 offen lds
    v_mfma_f32_32x32x16_bf16 v[80:95], v[196:199], v[212:215], v[80:95]
    v_mfma_f32_32x32x16_bf16 v[96:111], v[200:203], v[212:215], v[96:111]
    v_mfma_f32_32x32x16_bf16 v[112:127], v[204:207], v[212:215], v[112:127]
    ds_read_b64_tr_b16 v[192:193], v128 offset:12288
    ds_read_b64_tr_b16 v[194:195], v128 offset:13312
    ds_read_b64_tr_b16 v[196:197], v129 offset:12288
    ds_read_b64_tr_b16 v[198:199], v129 offset:13312
    ds_read_b64_tr_b16 v[200:201], v130 offset:12288
    ds_read_b64_tr_b16 v[202:203], v130 offset:13312
    ds_read_b64_tr_b16 v[204:205], v131 offset:12288
    s_waitcnt lgkmcnt(14)
    ds_read_b64_tr_b16 v[206:207], v131 offset:13312
    s_waitcnt lgkmcnt(8)
    v_mfma_f32_32x32x16_bf16 v[64:79], v[176:179], v[216:219], v[64:79]
    s_add_u32 m0, s30, 101376
    s_add_u32 s33, s28, 4292608
    buffer_load_dwordx4 v152, s[16:19], s33 offen lds
    v_mfma_f32_32x32x16_bf16 v[80:95], v[180:183], v[216:219], v[80:95]
    v_mfma_f32_32x32x16_bf16 v[96:111], v[184:187], v[216:219], v[96:111]
    v_mfma_f32_32x32x16_bf16 v[112:127], v[188:191], v[216:219], v[112:127]
    s_waitcnt lgkmcnt(0)
    s_waitcnt vmcnt(4)
    s_barrier
    ds_read_b128 v[208:211], v144
    ds_read_b64_tr_b16 v[176:177], v132
    ds_read_b64_tr_b16 v[178:179], v132 offset:1024
    ds_read_b64_tr_b16 v[180:181], v133
    ds_read_b64_tr_b16 v[182:183], v133 offset:1024
    ds_read_b64_tr_b16 v[184:185], v134
    ds_read_b64_tr_b16 v[186:187], v134 offset:1024
    ds_read_b64_tr_b16 v[188:189], v135
    ds_read_b64_tr_b16 v[190:191], v135 offset:1024
    v_mfma_f32_32x32x16_bf16 v[64:79], v[192:195], v[220:223], v[64:79]
    s_add_u32 m0, s30, 0
    s_add_u32 s33, s28, 4718592
    buffer_load_dwordx4 v152, s[16:19], s33 offen lds
    v_mfma_f32_32x32x16_bf16 v[80:95], v[196:199], v[220:223], v[80:95]
    v_mfma_f32_32x32x16_bf16 v[96:111], v[200:203], v[220:223], v[96:111]
    v_mfma_f32_32x32x16_bf16 v[112:127], v[204:207], v[220:223], v[112:127]
    ds_read_b128 v[212:215], v145
    ds_read_b128 v[216:219], v146
    ds_read_b128 v[220:223], v147
    s_waitcnt lgkmcnt(3)
    ds_read_b64_tr_b16 v[192:193], v132 offset:4096
    ds_read_b64_tr_b16 v[194:195], v132 offset:5120
    ds_read_b64_tr_b16 v[196:197], v133 offset:4096
    ds_read_b64_tr_b16 v[198:199], v133 offset:5120
    ds_read_b64_tr_b16 v[200:201], v134 offset:4096
    ds_read_b64_tr_b16 v[202:203], v134 offset:5120
    ds_read_b64_tr_b16 v[204:205], v135 offset:4096
    ds_read_b64_tr_b16 v[206:207], v135 offset:5120
    v_mfma_f32_32x32x16_bf16 v[64:79], v[176:179], v[208:211], v[64:79]
    s_add_u32 m0, s30, 1024
    s_add_u32 s33, s28, 4751360
    buffer_load_dwordx4 v152, s[16:19], s33 offen lds
    v_mfma_f32_32x32x16_bf16 v[80:95], v[180:183], v[208:211], v[80:95]
    v_mfma_f32_32x32x16_bf16 v[96:111], v[184:187], v[208:211], v[96:111]
    v_mfma_f32_32x32x16_bf16 v[112:127], v[188:191], v[208:211], v[112:127]
    ds_read_b64_tr_b16 v[176:177], v132 offset:8192
    ds_read_b64_tr_b16 v[178:179], v132 offset:9216
    ds_read_b64_tr_b16 v[180:181], v133 offset:8192
    ds_read_b64_tr_b16 v[182:183], v133 offset:9216
    s_waitcnt lgkmcnt(14)
    ds_read_b64_tr_b16 v[184:185], v134 offset:8192
    s_waitcnt lgkmcnt(14)
    ds_read_b64_tr_b16 v[186:187], v134 offset:9216
    s_waitcnt lgkmcnt(14)
    ds_read_b64_tr_b16 v[188:189], v135 offset:8192
    s_waitcnt lgkmcnt(14)
    ds_read_b64_tr_b16 v[190:191], v135 offset:9216
    s_waitcnt lgkmcnt(8)
    v_mfma_f32_32x32x16_bf16 v[64:79], v[192:195], v[212:215], v[64:79]
    s_add_u32 m0, s30, 2048
    s_add_u32 s33, s28, 4784128
    buffer_load_dwordx4 v152, s[16:19], s33 offen lds
    v_mfma_f32_32x32x16_bf16 v[80:95], v[196:199], v[212:215], v[80:95]
    v_mfma_f32_32x32x16_bf16 v[96:111], v[200:203], v[212:215], v[96:111]
    v_mfma_f32_32x32x16_bf16 v[112:127], v[204:207], v[212:215], v[112:127]
    ds_read_b64_tr_b16 v[192:193], v132 offset:12288
    ds_read_b64_tr_b16 v[194:195], v132 offset:13312
    ds_read_b64_tr_b16 v[196:197], v133 offset:12288
    ds_read_b64_tr_b16 v[198:199], v133 offset:13312
    ds_read_b64_tr_b16 v[200:201], v134 offset:12288
    ds_read_b64_tr_b16 v[202:203], v134 offset:13312
    ds_read_b64_tr_b16 v[204:205], v135 offset:12288
    s_waitcnt lgkmcnt(14)
    ds_read_b64_tr_b16 v[206:207], v135 offset:13312
    s_waitcnt lgkmcnt(8)
    v_mfma_f32_32x32x16_bf16 v[64:79], v[176:179], v[216:219], v[64:79]
    s_add_u32 m0, s30, 3072
    s_add_u32 s33, s28, 4816896
    buffer_load_dwordx4 v152, s[16:19], s33 offen lds
    v_mfma_f32_32x32x16_bf16 v[80:95], v[180:183], v[216:219], v[80:95]
    v_mfma_f32_32x32x16_bf16 v[96:111], v[184:187], v[216:219], v[96:111]
    v_mfma_f32_32x32x16_bf16 v[112:127], v[188:191], v[216:219], v[112:127]
    s_waitcnt lgkmcnt(0)
    s_waitcnt vmcnt(4)
    s_barrier
    ds_read_b128 v[208:211], v148
    ds_read_b64_tr_b16 v[176:177], v136
    ds_read_b64_tr_b16 v[178:179], v136 offset:1024
    ds_read_b64_tr_b16 v[180:181], v137
    ds_read_b64_tr_b16 v[182:183], v137 offset:1024
    ds_read_b64_tr_b16 v[184:185], v138
    ds_read_b64_tr_b16 v[186:187], v138 offset:1024
    ds_read_b64_tr_b16 v[188:189], v139
    ds_read_b64_tr_b16 v[190:191], v139 offset:1024
    v_mfma_f32_32x32x16_bf16 v[64:79], v[192:195], v[220:223], v[64:79]
    v_mfma_f32_32x32x16_bf16 v[80:95], v[196:199], v[220:223], v[80:95]
    v_mfma_f32_32x32x16_bf16 v[96:111], v[200:203], v[220:223], v[96:111]
    v_mfma_f32_32x32x16_bf16 v[112:127], v[204:207], v[220:223], v[112:127]
    ds_read_b128 v[212:215], v149
    ds_read_b128 v[216:219], v150
    ds_read_b128 v[220:223], v151
    s_waitcnt lgkmcnt(3)
    ds_read_b64_tr_b16 v[192:193], v136 offset:4096
    ds_read_b64_tr_b16 v[194:195], v136 offset:5120
    ds_read_b64_tr_b16 v[196:197], v137 offset:4096
    ds_read_b64_tr_b16 v[198:199], v137 offset:5120
    ds_read_b64_tr_b16 v[200:201], v138 offset:4096
    ds_read_b64_tr_b16 v[202:203], v138 offset:5120
    ds_read_b64_tr_b16 v[204:205], v139 offset:4096
    ds_read_b64_tr_b16 v[206:207], v139 offset:5120
    v_mfma_f32_32x32x16_bf16 v[64:79], v[176:179], v[208:211], v[64:79]
    v_mfma_f32_32x32x16_bf16 v[80:95], v[180:183], v[208:211], v[80:95]
    v_mfma_f32_32x32x16_bf16 v[96:111], v[184:187], v[208:211], v[96:111]
    v_mfma_f32_32x32x16_bf16 v[112:127], v[188:191], v[208:211], v[112:127]
    ds_read_b64_tr_b16 v[176:177], v136 offset:8192
    ds_read_b64_tr_b16 v[178:179], v136 offset:9216
    ds_read_b64_tr_b16 v[180:181], v137 offset:8192
    ds_read_b64_tr_b16 v[182:183], v137 offset:9216
    s_waitcnt lgkmcnt(14)
    ds_read_b64_tr_b16 v[184:185], v138 offset:8192
    s_waitcnt lgkmcnt(14)
    ds_read_b64_tr_b16 v[186:187], v138 offset:9216
    s_waitcnt lgkmcnt(14)
    ds_read_b64_tr_b16 v[188:189], v139 offset:8192
    s_waitcnt lgkmcnt(14)
    ds_read_b64_tr_b16 v[190:191], v139 offset:9216
    s_waitcnt lgkmcnt(8)
    v_mfma_f32_32x32x16_bf16 v[64:79], v[192:195], v[212:215], v[64:79]
    v_mfma_f32_32x32x16_bf16 v[80:95], v[196:199], v[212:215], v[80:95]
    v_mfma_f32_32x32x16_bf16 v[96:111], v[200:203], v[212:215], v[96:111]
    v_mfma_f32_32x32x16_bf16 v[112:127], v[204:207], v[212:215], v[112:127]
    ds_read_b64_tr_b16 v[192:193], v136 offset:12288
    ds_read_b64_tr_b16 v[194:195], v136 offset:13312
    ds_read_b64_tr_b16 v[196:197], v137 offset:12288
    ds_read_b64_tr_b16 v[198:199], v137 offset:13312
    ds_read_b64_tr_b16 v[200:201], v138 offset:12288
    ds_read_b64_tr_b16 v[202:203], v138 offset:13312
    ds_read_b64_tr_b16 v[204:205], v139 offset:12288
    s_waitcnt lgkmcnt(14)
    ds_read_b64_tr_b16 v[206:207], v139 offset:13312
    s_waitcnt lgkmcnt(8)
    v_mfma_f32_32x32x16_bf16 v[64:79], v[176:179], v[216:219], v[64:79]
    v_mfma_f32_32x32x16_bf16 v[80:95], v[180:183], v[216:219], v[80:95]
    v_mfma_f32_32x32x16_bf16 v[96:111], v[184:187], v[216:219], v[96:111]
    v_mfma_f32_32x32x16_bf16 v[112:127], v[188:191], v[216:219], v[112:127]
    s_waitcnt lgkmcnt(0)
    s_waitcnt vmcnt(0)
    s_barrier
    ds_read_b128 v[208:211], v140
    ds_read_b64_tr_b16 v[176:177], v128
    ds_read_b64_tr_b16 v[178:179], v128 offset:1024
    ds_read_b64_tr_b16 v[180:181], v129
    ds_read_b64_tr_b16 v[182:183], v129 offset:1024
    ds_read_b64_tr_b16 v[184:185], v130
    ds_read_b64_tr_b16 v[186:187], v130 offset:1024
    ds_read_b64_tr_b16 v[188:189], v131
    ds_read_b64_tr_b16 v[190:191], v131 offset:1024
    v_mfma_f32_32x32x16_bf16 v[64:79], v[192:195], v[220:223], v[64:79]
    v_mfma_f32_32x32x16_bf16 v[80:95], v[196:199], v[220:223], v[80:95]
    v_mfma_f32_32x32x16_bf16 v[96:111], v[200:203], v[220:223], v[96:111]
    v_mfma_f32_32x32x16_bf16 v[112:127], v[204:207], v[220:223], v[112:127]
    ds_read_b128 v[212:215], v141
    ds_read_b128 v[216:219], v142
    ds_read_b128 v[220:223], v143
    s_waitcnt lgkmcnt(3)
    ds_read_b64_tr_b16 v[192:193], v128 offset:4096
    ds_read_b64_tr_b16 v[194:195], v128 offset:5120
    ds_read_b64_tr_b16 v[196:197], v129 offset:4096
    ds_read_b64_tr_b16 v[198:199], v129 offset:5120
    ds_read_b64_tr_b16 v[200:201], v130 offset:4096
    ds_read_b64_tr_b16 v[202:203], v130 offset:5120
    ds_read_b64_tr_b16 v[204:205], v131 offset:4096
    ds_read_b64_tr_b16 v[206:207], v131 offset:5120
    v_mfma_f32_32x32x16_bf16 v[64:79], v[176:179], v[208:211], v[64:79]
    v_mfma_f32_32x32x16_bf16 v[80:95], v[180:183], v[208:211], v[80:95]
    v_mfma_f32_32x32x16_bf16 v[96:111], v[184:187], v[208:211], v[96:111]
    v_mfma_f32_32x32x16_bf16 v[112:127], v[188:191], v[208:211], v[112:127]
    ds_read_b64_tr_b16 v[176:177], v128 offset:8192
    ds_read_b64_tr_b16 v[178:179], v128 offset:9216
    ds_read_b64_tr_b16 v[180:181], v129 offset:8192
    ds_read_b64_tr_b16 v[182:183], v129 offset:9216
    s_waitcnt lgkmcnt(14)
    ds_read_b64_tr_b16 v[184:185], v130 offset:8192
    s_waitcnt lgkmcnt(14)
    ds_read_b64_tr_b16 v[186:187], v130 offset:9216
    s_waitcnt lgkmcnt(14)
    ds_read_b64_tr_b16 v[188:189], v131 offset:8192
    s_waitcnt lgkmcnt(14)
    ds_read_b64_tr_b16 v[190:191], v131 offset:9216
    s_waitcnt lgkmcnt(8)
    v_mfma_f32_32x32x16_bf16 v[64:79], v[192:195], v[212:215], v[64:79]
    v_mfma_f32_32x32x16_bf16 v[80:95], v[196:199], v[212:215], v[80:95]
    v_mfma_f32_32x32x16_bf16 v[96:111], v[200:203], v[212:215], v[96:111]
    v_mfma_f32_32x32x16_bf16 v[112:127], v[204:207], v[212:215], v[112:127]
    ds_read_b64_tr_b16 v[192:193], v128 offset:12288
    ds_read_b64_tr_b16 v[194:195], v128 offset:13312
    ds_read_b64_tr_b16 v[196:197], v129 offset:12288
    ds_read_b64_tr_b16 v[198:199], v129 offset:13312
    ds_read_b64_tr_b16 v[200:201], v130 offset:12288
    ds_read_b64_tr_b16 v[202:203], v130 offset:13312
    ds_read_b64_tr_b16 v[204:205], v131 offset:12288
    s_waitcnt lgkmcnt(14)
    ds_read_b64_tr_b16 v[206:207], v131 offset:13312
    s_waitcnt lgkmcnt(8)
    v_mfma_f32_32x32x16_bf16 v[64:79], v[176:179], v[216:219], v[64:79]
    v_mfma_f32_32x32x16_bf16 v[80:95], v[180:183], v[216:219], v[80:95]
    v_mfma_f32_32x32x16_bf16 v[96:111], v[184:187], v[216:219], v[96:111]
    v_mfma_f32_32x32x16_bf16 v[112:127], v[188:191], v[216:219], v[112:127]
    s_waitcnt lgkmcnt(0)
    v_mfma_f32_32x32x16_bf16 v[64:79], v[192:195], v[220:223], v[64:79]
    v_mfma_f32_32x32x16_bf16 v[80:95], v[196:199], v[220:223], v[80:95]
    v_mfma_f32_32x32x16_bf16 v[96:111], v[200:203], v[220:223], v[96:111]
    v_mfma_f32_32x32x16_bf16 v[112:127], v[204:207], v[220:223], v[112:127]
    s_nop 8
    v_mul_f32 v64, s48, v64
    v_mul_f32 v65, s48, v65
    v_mul_f32 v66, s48, v66
    v_mul_f32 v67, s48, v67
    v_mul_f32 v68, s48, v68
    v_mul_f32 v69, s48, v69
    v_mul_f32 v70, s48, v70
    v_mul_f32 v71, s48, v71
    v_cvt_pk_bf16_f32 v32, v64, v65
    v_cvt_pk_bf16_f32 v33, v66, v67
    v_cvt_pk_bf16_f32 v34, v68, v69
    v_cvt_pk_bf16_f32 v35, v70, v71
    v_mul_f32 v72, s48, v72
    v_mul_f32 v73, s48, v73
    v_mul_f32 v74, s48, v74
    v_mul_f32 v75, s48, v75
    v_mul_f32 v76, s48, v76
    v_mul_f32 v77, s48, v77
    v_mul_f32 v78, s48, v78
    v_mul_f32 v79, s48, v79
    v_cvt_pk_bf16_f32 v36, v72, v73
    v_cvt_pk_bf16_f32 v37, v74, v75
    v_cvt_pk_bf16_f32 v38, v76, v77
    v_cvt_pk_bf16_f32 v39, v78, v79
    v_mul_f32 v80, s48, v80
    v_mul_f32 v81, s48, v81
    v_mul_f32 v82, s48, v82
    v_mul_f32 v83, s48, v83
    v_mul_f32 v84, s48, v84
    v_mul_f32 v85, s48, v85
    v_mul_f32 v86, s48, v86
    v_mul_f32 v87, s48, v87
    v_cvt_pk_bf16_f32 v40, v80, v81
    v_cvt_pk_bf16_f32 v41, v82, v83
    v_cvt_pk_bf16_f32 v42, v84, v85
    v_cvt_pk_bf16_f32 v43, v86, v87
    v_mul_f32 v88, s48, v88
    v_mul_f32 v89, s48, v89
    v_mul_f32 v90, s48, v90
    v_mul_f32 v91, s48, v91
    v_mul_f32 v92, s48, v92
    v_mul_f32 v93, s48, v93
    v_mul_f32 v94, s48, v94
    v_mul_f32 v95, s48, v95
    v_cvt_pk_bf16_f32 v44, v88, v89
    v_cvt_pk_bf16_f32 v45, v90, v91
    v_cvt_pk_bf16_f32 v46, v92, v93
    v_cvt_pk_bf16_f32 v47, v94, v95
    v_mul_f32 v96, s48, v96
    v_mul_f32 v97, s48, v97
    v_mul_f32 v98, s48, v98
    v_mul_f32 v99, s48, v99
    v_mul_f32 v100, s48, v100
    v_mul_f32 v101, s48, v101
    v_mul_f32 v102, s48, v102
    v_mul_f32 v103, s48, v103
    v_cvt_pk_bf16_f32 v48, v96, v97
    v_cvt_pk_bf16_f32 v49, v98, v99
    v_cvt_pk_bf16_f32 v50, v100, v101
    v_cvt_pk_bf16_f32 v51, v102, v103
    v_mul_f32 v104, s48, v104
    v_mul_f32 v105, s48, v105
    v_mul_f32 v106, s48, v106
    v_mul_f32 v107, s48, v107
    v_mul_f32 v108, s48, v108
    v_mul_f32 v109, s48, v109
    v_mul_f32 v110, s48, v110
    v_mul_f32 v111, s48, v111
    v_cvt_pk_bf16_f32 v52, v104, v105
    v_cvt_pk_bf16_f32 v53, v106, v107
    v_cvt_pk_bf16_f32 v54, v108, v109
    v_cvt_pk_bf16_f32 v55, v110, v111
    v_mul_f32 v112, s48, v112
    v_mul_f32 v113, s48, v113
    v_mul_f32 v114, s48, v114
    v_mul_f32 v115, s48, v115
    v_mul_f32 v116, s48, v116
    v_mul_f32 v117, s48, v117
    v_mul_f32 v118, s48, v118
    v_mul_f32 v119, s48, v119
    v_cvt_pk_bf16_f32 v56, v112, v113
    v_cvt_pk_bf16_f32 v57, v114, v115
    v_cvt_pk_bf16_f32 v58, v116, v117
    v_cvt_pk_bf16_f32 v59, v118, v119
    v_mul_f32 v120, s48, v120
    v_mul_f32 v121, s48, v121
    v_mul_f32 v122, s48, v122
    v_mul_f32 v123, s48, v123
    v_mul_f32 v124, s48, v124
    v_mul_f32 v125, s48, v125
    v_mul_f32 v126, s48, v126
    v_mul_f32 v127, s48, v127
    v_cvt_pk_bf16_f32 v60, v120, v121
    v_cvt_pk_bf16_f32 v61, v122, v123
    v_cvt_pk_bf16_f32 v62, v124, v125
    v_cvt_pk_bf16_f32 v63, v126, v127
standalone__mha_block_cached__near_ridge_kernel_Apair:
    s_barrier
    s_cmp_eq_u32 s46, 0
    s_cbranch_scc1 standalone__mha_block_cached__near_ridge_kernel_noq
    ds_read_b128 v[32:35], v14
    ds_read_b128 v[36:39], v14 offset:1024
    ds_read_b128 v[40:43], v14 offset:2048
    ds_read_b128 v[44:47], v14 offset:3072
    ds_read_b128 v[48:51], v14 offset:4096
    ds_read_b128 v[52:55], v14 offset:5120
    ds_read_b128 v[56:59], v14 offset:6144
    ds_read_b128 v[60:63], v14 offset:7168
    s_waitcnt lgkmcnt(0)
standalone__mha_block_cached__near_ridge_kernel_noq:
    ds_read_b128 v[176:179], v240
    ds_read_b128 v[180:183], v241
    ds_read_b128 v[184:187], v242
    ds_read_b128 v[188:191], v243
    ds_read_b128 v[192:195], v244
    ds_read_b128 v[196:199], v245
    ds_read_b128 v[200:203], v246
    ds_read_b128 v[204:207], v247
    v_mov_b32 v2, 0
    v_mov_b32 v3, 0
    s_waitcnt lgkmcnt(4)
    v_mfma_f32_32x32x16_bf16 v[128:143], v[176:179], v[32:35], 0
    ds_read_b128 v[176:179], v240 offset:8192
    v_mfma_f32_32x32x16_bf16 v[128:143], v[180:183], v[36:39], v[128:143]
    ds_read_b128 v[180:183], v241 offset:8192
    v_mfma_f32_32x32x16_bf16 v[128:143], v[184:187], v[40:43], v[128:143]
    ds_read_b128 v[184:187], v242 offset:8192
    v_mfma_f32_32x32x16_bf16 v[128:143], v[188:191], v[44:47], v[128:143]
    ds_read_b128 v[188:191], v243 offset:8192
    s_waitcnt lgkmcnt(4)
    v_mfma_f32_32x32x16_bf16 v[128:143], v[192:195], v[48:51], v[128:143]
    ds_read_b128 v[192:195], v244 offset:8192
    v_mfma_f32_32x32x16_bf16 v[128:143], v[196:199], v[52:55], v[128:143]
    ds_read_b128 v[196:199], v245 offset:8192
    v_mfma_f32_32x32x16_bf16 v[128:143], v[200:203], v[56:59], v[128:143]
    ds_read_b128 v[200:203], v246 offset:8192
    v_mfma_f32_32x32x16_bf16 v[128:143], v[204:207], v[60:63], v[128:143]
    ds_read_b128 v[204:207], v247 offset:8192
    s_nop 10
    v_max3_f32 v4, v128, v129, v130
    v_max3_f32 v4, v4, v131, v132
    v_max3_f32 v4, v4, v133, v134
    v_max3_f32 v4, v4, v135, v136
    v_max3_f32 v4, v4, v137, v138
    v_max3_f32 v4, v4, v139, v140
    v_max3_f32 v4, v4, v141, v142
    v_max_f32 v4, v4, v143
    v_mov_b32 v5, v4
    s_nop 1
    v_permlane32_swap_b32 v4, v5
    v_max_f32 v4, v4, v5
    v_sub_f32 v16, 0, v4
    v_sub_f32 v17, 0, v4
    v_sub_f32 v18, 0, v4
    v_sub_f32 v19, 0, v4
    v_sub_f32 v20, 0, v4
    v_sub_f32 v21, 0, v4
    v_sub_f32 v22, 0, v4
    v_sub_f32 v23, 0, v4
    v_sub_f32 v24, 0, v4
    v_sub_f32 v25, 0, v4
    v_sub_f32 v26, 0, v4
    v_sub_f32 v27, 0, v4
    v_sub_f32 v28, 0, v4
    v_sub_f32 v29, 0, v4
    v_sub_f32 v30, 0, v4
    v_sub_f32 v31, 0, v4
    v_sub_f32 v128, v128, v4
    v_sub_f32 v129, v129, v4
    v_sub_f32 v130, v130, v4
    v_sub_f32 v131, v131, v4
    v_sub_f32 v132, v132, v4
    v_sub_f32 v133, v133, v4
    v_sub_f32 v134, v134, v4
    v_sub_f32 v135, v135, v4
    v_sub_f32 v136, v136, v4
    v_sub_f32 v137, v137, v4
    v_sub_f32 v138, v138, v4
    v_sub_f32 v139, v139, v4
    v_sub_f32 v140, v140, v4
    v_sub_f32 v141, v141, v4
    v_sub_f32 v142, v142, v4
    v_sub_f32 v143, v143, v4
    ds_read_b64_tr_b16 v[208:209], v248
    ds_read_b64_tr_b16 v[210:211], v248 offset:2048
    ds_read_b64_tr_b16 v[212:213], v249
    ds_read_b64_tr_b16 v[214:215], v249 offset:2048
    s_waitcnt lgkmcnt(4)
    ds_read_b64_tr_b16 v[216:217], v250
    ds_read_b64_tr_b16 v[218:219], v250 offset:2048
    v_exp_f32 v128, v128
    v_exp_f32 v129, v129
    v_exp_f32 v130, v130
    v_exp_f32 v131, v131
    ds_read_b64_tr_b16 v[220:221], v251
    ds_read_b64_tr_b16 v[222:223], v251 offset:2048
    v_add_f32 v2, v2, v128
    v_add_f32 v3, v3, v129
    v_cvt_pk_bf16_f32 v160, v128, v129
    v_exp_f32 v132, v132
    ds_read_b64_tr_b16 v[224:225], v248 offset:4096
    ds_read_b64_tr_b16 v[226:227], v248 offset:6144
    v_exp_f32 v133, v133
    v_add_f32 v2, v2, v130
    v_add_f32 v3, v3, v131
    s_waitcnt lgkmcnt(6)
    ds_read_b64_tr_b16 v[228:229], v249 offset:4096
    ds_read_b64_tr_b16 v[230:231], v249 offset:6144
    v_cvt_pk_bf16_f32 v161, v130, v131
    v_exp_f32 v134, v134
    v_exp_f32 v135, v135
    ds_read_b64_tr_b16 v[232:233], v250 offset:4096
    ds_read_b64_tr_b16 v[234:235], v250 offset:6144
    v_add_f32 v2, v2, v132
    v_add_f32 v3, v3, v133
    v_cvt_pk_bf16_f32 v162, v132, v133
    ds_read_b64_tr_b16 v[236:237], v251 offset:4096
    ds_read_b64_tr_b16 v[238:239], v251 offset:6144
    v_add_f32 v2, v2, v134
    v_add_f32 v3, v3, v135
    v_cvt_pk_bf16_f32 v163, v134, v135
    s_waitcnt lgkmcnt(6)
    v_mfma_f32_32x32x16_bf16 v[144:159], v[176:179], v[32:35], v[16:31]
    ds_read_b64_tr_b16 v[176:177], v248 offset:8192
    ds_read_b64_tr_b16 v[178:179], v248 offset:10240
    v_exp_f32 v136, v136
    v_exp_f32 v137, v137
    v_exp_f32 v138, v138
    v_mfma_f32_32x32x16_bf16 v[144:159], v[180:183], v[36:39], v[144:159]
    ds_read_b64_tr_b16 v[180:181], v249 offset:8192
    ds_read_b64_tr_b16 v[182:183], v249 offset:10240
    v_exp_f32 v139, v139
    v_add_f32 v2, v2, v136
    v_add_f32 v3, v3, v137
    v_mfma_f32_32x32x16_bf16 v[144:159], v[184:187], v[40:43], v[144:159]
    ds_read_b64_tr_b16 v[184:185], v250 offset:8192
    ds_read_b64_tr_b16 v[186:187], v250 offset:10240
    v_cvt_pk_bf16_f32 v164, v136, v137
    v_exp_f32 v140, v140
    v_exp_f32 v141, v141
    s_waitcnt lgkmcnt(6)
    v_mfma_f32_32x32x16_bf16 v[144:159], v[188:191], v[44:47], v[144:159]
    ds_read_b64_tr_b16 v[188:189], v251 offset:8192
    ds_read_b64_tr_b16 v[190:191], v251 offset:10240
    v_add_f32 v2, v2, v138
    v_add_f32 v3, v3, v139
    v_cvt_pk_bf16_f32 v165, v138, v139
    v_mfma_f32_32x32x16_bf16 v[144:159], v[192:195], v[48:51], v[144:159]
    ds_read_b64_tr_b16 v[192:193], v248 offset:12288
    ds_read_b64_tr_b16 v[194:195], v248 offset:14336
    v_exp_f32 v142, v142
    v_exp_f32 v143, v143
    v_mfma_f32_32x32x16_bf16 v[144:159], v[196:199], v[52:55], v[144:159]
    ds_read_b64_tr_b16 v[196:197], v249 offset:12288
    ds_read_b64_tr_b16 v[198:199], v249 offset:14336
    v_add_f32 v2, v2, v140
    v_add_f32 v3, v3, v141
    s_waitcnt lgkmcnt(6)
    v_mfma_f32_32x32x16_bf16 v[144:159], v[200:203], v[56:59], v[144:159]
    ds_read_b64_tr_b16 v[200:201], v250 offset:12288
    ds_read_b64_tr_b16 v[202:203], v250 offset:14336
    v_cvt_pk_bf16_f32 v166, v140, v141
    v_add_f32 v2, v2, v142
    v_mfma_f32_32x32x16_bf16 v[144:159], v[204:207], v[60:63], v[144:159]
    ds_read_b64_tr_b16 v[204:205], v251 offset:12288
    ds_read_b64_tr_b16 v[206:207], v251 offset:14336
    v_add_f32 v3, v3, v143
    v_cvt_pk_bf16_f32 v167, v142, v143
    s_add_u32 s35, s35, 1
    s_cmp_eq_u32 s35, 3
    s_cselect_b32 s33, s49, s50
    s_cselect_b32 s35, 0, s35
    v_mfma_f32_32x32x16_bf16 v[64:79], v[208:211], v[160:163], 0
    v_add_u32 v240, s33, v240
    v_add_u32 v241, s33, v241
    v_add_u32 v242, s33, v242
    v_add_u32 v243, s33, v243
    v_add_u32 v244, s33, v244
    v_add_u32 v245, s33, v245
    v_mfma_f32_32x32x16_bf16 v[80:95], v[212:215], v[160:163], 0
    v_add_u32 v246, s33, v246
    v_add_u32 v247, s33, v247
    v_add_u32 v248, s33, v248
    v_add_u32 v249, s33, v249
    v_add_u32 v250, s33, v250
    v_add_u32 v251, s33, v251
    v_mfma_f32_32x32x16_bf16 v[96:111], v[216:219], v[160:163], 0
    v_exp_f32 v144, v144
    v_exp_f32 v145, v145
    v_exp_f32 v146, v146
    v_exp_f32 v147, v147
    v_mfma_f32_32x32x16_bf16 v[112:127], v[220:223], v[160:163], 0
    v_add_f32 v2, v2, v144
    v_add_f32 v3, v3, v145
    v_cvt_pk_bf16_f32 v168, v144, v145
    v_exp_f32 v148, v148
    v_mfma_f32_32x32x16_bf16 v[64:79], v[224:227], v[164:167], v[64:79]
    v_exp_f32 v149, v149
    v_add_f32 v2, v2, v146
    v_add_f32 v3, v3, v147
    v_mfma_f32_32x32x16_bf16 v[80:95], v[228:231], v[164:167], v[80:95]
    v_cvt_pk_bf16_f32 v169, v146, v147
    v_exp_f32 v150, v150
    v_exp_f32 v151, v151
    v_mfma_f32_32x32x16_bf16 v[96:111], v[232:235], v[164:167], v[96:111]
    v_add_f32 v2, v2, v148
    v_add_f32 v3, v3, v149
    v_cvt_pk_bf16_f32 v170, v148, v149
    v_mfma_f32_32x32x16_bf16 v[112:127], v[236:239], v[164:167], v[112:127]
    v_add_f32 v2, v2, v150
    v_add_f32 v3, v3, v151
    v_cvt_pk_bf16_f32 v171, v150, v151
    s_waitcnt lgkmcnt(0)
    s_mov_b32 s47, 8
standalone__mha_block_cached__near_ridge_kernel_Aloop:
    s_barrier
    ds_read_b128 v[208:211], v240
    ds_read_b128 v[212:215], v241
    ds_read_b128 v[216:219], v242
    ds_read_b128 v[220:223], v243
    ds_read_b128 v[224:227], v244
    ds_read_b128 v[228:231], v245
    ds_read_b128 v[232:235], v246
    ds_read_b128 v[236:239], v247
    v_exp_f32 v152, v152
    v_exp_f32 v153, v153
    v_exp_f32 v154, v154
    v_exp_f32 v155, v155
    v_add_f32 v2, v2, v152
    v_add_f32 v3, v3, v153
    v_cvt_pk_bf16_f32 v172, v152, v153
    v_exp_f32 v156, v156
    v_exp_f32 v157, v157
    v_add_f32 v2, v2, v154
    v_add_f32 v3, v3, v155
    v_cvt_pk_bf16_f32 v173, v154, v155
    s_waitcnt lgkmcnt(4)
    v_mfma_f32_32x32x16_bf16 v[128:143], v[208:211], v[32:35], v[16:31]
    ds_read_b128 v[208:211], v240 offset:8192
    v_exp_f32 v158, v158
    v_exp_f32 v159, v159
    v_mfma_f32_32x32x16_bf16 v[128:143], v[212:215], v[36:39], v[128:143]
    ds_read_b128 v[212:215], v241 offset:8192
    v_add_f32 v2, v2, v156
    v_add_f32 v3, v3, v157
    v_mfma_f32_32x32x16_bf16 v[128:143], v[216:219], v[40:43], v[128:143]
    ds_read_b128 v[216:219], v242 offset:8192
    v_cvt_pk_bf16_f32 v174, v156, v157
    v_add_f32 v2, v2, v158
    v_mfma_f32_32x32x16_bf16 v[128:143], v[220:223], v[44:47], v[128:143]
    ds_read_b128 v[220:223], v243 offset:8192
    v_add_f32 v3, v3, v159
    v_cvt_pk_bf16_f32 v175, v158, v159
    s_waitcnt lgkmcnt(4)
    v_mfma_f32_32x32x16_bf16 v[128:143], v[224:227], v[48:51], v[128:143]
    ds_read_b128 v[224:227], v244 offset:8192
    v_mfma_f32_32x32x16_bf16 v[128:143], v[228:231], v[52:55], v[128:143]
    ds_read_b128 v[228:231], v245 offset:8192
    v_mfma_f32_32x32x16_bf16 v[128:143], v[232:235], v[56:59], v[128:143]
    ds_read_b128 v[232:235], v246 offset:8192
    v_mfma_f32_32x32x16_bf16 v[128:143], v[236:239], v[60:63], v[128:143]
    ds_read_b128 v[236:239], v247 offset:8192
    v_mfma_f32_32x32x16_bf16 v[64:79], v[176:179], v[168:171], v[64:79]
    ds_read_b64_tr_b16 v[176:177], v248
    ds_read_b64_tr_b16 v[178:179], v248 offset:2048
    v_mfma_f32_32x32x16_bf16 v[80:95], v[180:183], v[168:171], v[80:95]
    ds_read_b64_tr_b16 v[180:181], v249
    ds_read_b64_tr_b16 v[182:183], v249 offset:2048
    s_waitcnt lgkmcnt(4)
    v_mfma_f32_32x32x16_bf16 v[96:111], v[184:187], v[168:171], v[96:111]
    ds_read_b64_tr_b16 v[184:185], v250
    ds_read_b64_tr_b16 v[186:187], v250 offset:2048
    s_nop 0
    v_exp_f32 v128, v128
    v_exp_f32 v129, v129
    v_exp_f32 v130, v130
    v_exp_f32 v131, v131
    v_mfma_f32_32x32x16_bf16 v[112:127], v[188:191], v[168:171], v[112:127]
    ds_read_b64_tr_b16 v[188:189], v251
    ds_read_b64_tr_b16 v[190:191], v251 offset:2048
    v_add_f32 v2, v2, v128
    v_add_f32 v3, v3, v129
    v_cvt_pk_bf16_f32 v160, v128, v129
    v_exp_f32 v132, v132
    v_mfma_f32_32x32x16_bf16 v[64:79], v[192:195], v[172:175], v[64:79]
    ds_read_b64_tr_b16 v[192:193], v248 offset:4096
    ds_read_b64_tr_b16 v[194:195], v248 offset:6144
    v_exp_f32 v133, v133
    v_add_f32 v2, v2, v130
    v_add_f32 v3, v3, v131
    s_waitcnt lgkmcnt(6)
    v_mfma_f32_32x32x16_bf16 v[80:95], v[196:199], v[172:175], v[80:95]
    ds_read_b64_tr_b16 v[196:197], v249 offset:4096
    ds_read_b64_tr_b16 v[198:199], v249 offset:6144
    v_cvt_pk_bf16_f32 v161, v130, v131
    v_exp_f32 v134, v134
    v_exp_f32 v135, v135
    v_mfma_f32_32x32x16_bf16 v[96:111], v[200:203], v[172:175], v[96:111]
    ds_read_b64_tr_b16 v[200:201], v250 offset:4096
    ds_read_b64_tr_b16 v[202:203], v250 offset:6144
    v_add_f32 v2, v2, v132
    v_add_f32 v3, v3, v133
    v_cvt_pk_bf16_f32 v162, v132, v133
    v_mfma_f32_32x32x16_bf16 v[112:127], v[204:207], v[172:175], v[112:127]
    ds_read_b64_tr_b16 v[204:205], v251 offset:4096
    ds_read_b64_tr_b16 v[206:207], v251 offset:6144
    v_add_f32 v2, v2, v134
    v_add_f32 v3, v3, v135
    v_cvt_pk_bf16_f32 v163, v134, v135
    s_waitcnt lgkmcnt(6)
    v_mfma_f32_32x32x16_bf16 v[144:159], v[208:211], v[32:35], v[16:31]
    ds_read_b64_tr_b16 v[208:209], v248 offset:8192
    ds_read_b64_tr_b16 v[210:211], v248 offset:10240
    v_exp_f32 v136, v136
    v_exp_f32 v137, v137
    v_exp_f32 v138, v138
    v_mfma_f32_32x32x16_bf16 v[144:159], v[212:215], v[36:39], v[144:159]
    ds_read_b64_tr_b16 v[212:213], v249 offset:8192
    ds_read_b64_tr_b16 v[214:215], v249 offset:10240
    v_exp_f32 v139, v139
    v_add_f32 v2, v2, v136
    v_add_f32 v3, v3, v137
    v_mfma_f32_32x32x16_bf16 v[144:159], v[216:219], v[40:43], v[144:159]
    ds_read_b64_tr_b16 v[216:217], v250 offset:8192
    ds_read_b64_tr_b16 v[218:219], v250 offset:10240
    v_cvt_pk_bf16_f32 v164, v136, v137
    v_exp_f32 v140, v140
    v_exp_f32 v141, v141
    s_waitcnt lgkmcnt(6)
    v_mfma_f32_32x32x16_bf16 v[144:159], v[220:223], v[44:47], v[144:159]
    ds_read_b64_tr_b16 v[220:221], v251 offset:8192
    ds_read_b64_tr_b16 v[222:223], v251 offset:10240
    v_add_f32 v2, v2, v138
    v_add_f32 v3, v3, v139
    v_cvt_pk_bf16_f32 v165, v138, v139
    v_mfma_f32_32x32x16_bf16 v[144:159], v[224:227], v[48:51], v[144:159]
    ds_read_b64_tr_b16 v[224:225], v248 offset:12288
    ds_read_b64_tr_b16 v[226:227], v248 offset:14336
    v_exp_f32 v142, v142
    v_exp_f32 v143, v143
    v_mfma_f32_32x32x16_bf16 v[144:159], v[228:231], v[52:55], v[144:159]
    ds_read_b64_tr_b16 v[228:229], v249 offset:12288
    ds_read_b64_tr_b16 v[230:231], v249 offset:14336
    v_add_f32 v2, v2, v140
    v_add_f32 v3, v3, v141
    s_waitcnt lgkmcnt(6)
    v_mfma_f32_32x32x16_bf16 v[144:159], v[232:235], v[56:59], v[144:159]
    ds_read_b64_tr_b16 v[232:233], v250 offset:12288
    ds_read_b64_tr_b16 v[234:235], v250 offset:14336
    v_cvt_pk_bf16_f32 v166, v140, v141
    v_add_f32 v2, v2, v142
    v_mfma_f32_32x32x16_bf16 v[144:159], v[236:239], v[60:63], v[144:159]
    ds_read_b64_tr_b16 v[236:237], v251 offset:12288
    ds_read_b64_tr_b16 v[238:239], v251 offset:14336
    v_add_f32 v3, v3, v143
    v_cvt_pk_bf16_f32 v167, v142, v143
    s_add_u32 s35, s35, 1
    s_cmp_eq_u32 s35, 3
    s_cselect_b32 s33, s49, s50
    s_cselect_b32 s35, 0, s35
    v_mfma_f32_32x32x16_bf16 v[64:79], v[176:179], v[160:163], v[64:79]
    v_add_u32 v240, s33, v240
    v_add_u32 v241, s33, v241
    v_add_u32 v242, s33, v242
    v_add_u32 v243, s33, v243
    v_add_u32 v244, s33, v244
    v_add_u32 v245, s33, v245
    v_mfma_f32_32x32x16_bf16 v[80:95], v[180:183], v[160:163], v[80:95]
    v_add_u32 v246, s33, v246
    v_add_u32 v247, s33, v247
    v_add_u32 v248, s33, v248
    v_add_u32 v249, s33, v249
    v_add_u32 v250, s33, v250
    v_add_u32 v251, s33, v251
    v_mfma_f32_32x32x16_bf16 v[96:111], v[184:187], v[160:163], v[96:111]
    v_exp_f32 v144, v144
    v_exp_f32 v145, v145
    v_exp_f32 v146, v146
    v_exp_f32 v147, v147
    v_mfma_f32_32x32x16_bf16 v[112:127], v[188:191], v[160:163], v[112:127]
    v_add_f32 v2, v2, v144
    v_add_f32 v3, v3, v145
    v_cvt_pk_bf16_f32 v168, v144, v145
    v_exp_f32 v148, v148
    v_mfma_f32_32x32x16_bf16 v[64:79], v[192:195], v[164:167], v[64:79]
    v_exp_f32 v149, v149
    v_add_f32 v2, v2, v146
    v_add_f32 v3, v3, v147
    v_mfma_f32_32x32x16_bf16 v[80:95], v[196:199], v[164:167], v[80:95]
    v_cvt_pk_bf16_f32 v169, v146, v147
    v_exp_f32 v150, v150
    v_exp_f32 v151, v151
    v_mfma_f32_32x32x16_bf16 v[96:111], v[200:203], v[164:167], v[96:111]
    v_add_f32 v2, v2, v148
    v_add_f32 v3, v3, v149
    v_cvt_pk_bf16_f32 v170, v148, v149
    v_mfma_f32_32x32x16_bf16 v[112:127], v[204:207], v[164:167], v[112:127]
    v_add_f32 v2, v2, v150
    v_add_f32 v3, v3, v151
    v_cvt_pk_bf16_f32 v171, v150, v151
    s_waitcnt lgkmcnt(0)
    s_cmp_lt_u32 s47, 8
    s_cbranch_scc1 standalone__mha_block_cached__near_ridge_kernel_Anw
    s_waitcnt vmcnt(0)
standalone__mha_block_cached__near_ridge_kernel_Anw:
    s_sub_u32 s47, s47, 1
    s_cmp_eq_u32 s47, 0
    s_cbranch_scc1 standalone__mha_block_cached__near_ridge_kernel_Aepi
    s_barrier
    ds_read_b128 v[176:179], v240
    ds_read_b128 v[180:183], v241
    ds_read_b128 v[184:187], v242
    ds_read_b128 v[188:191], v243
    ds_read_b128 v[192:195], v244
    ds_read_b128 v[196:199], v245
    ds_read_b128 v[200:203], v246
    ds_read_b128 v[204:207], v247
    v_exp_f32 v152, v152
    v_exp_f32 v153, v153
    v_exp_f32 v154, v154
    v_exp_f32 v155, v155
    v_add_f32 v2, v2, v152
    v_add_f32 v3, v3, v153
    v_cvt_pk_bf16_f32 v172, v152, v153
    v_exp_f32 v156, v156
    v_exp_f32 v157, v157
    v_add_f32 v2, v2, v154
    v_add_f32 v3, v3, v155
    v_cvt_pk_bf16_f32 v173, v154, v155
    s_waitcnt lgkmcnt(4)
    v_mfma_f32_32x32x16_bf16 v[128:143], v[176:179], v[32:35], v[16:31]
    ds_read_b128 v[176:179], v240 offset:8192
    v_exp_f32 v158, v158
    v_exp_f32 v159, v159
    v_mfma_f32_32x32x16_bf16 v[128:143], v[180:183], v[36:39], v[128:143]
    ds_read_b128 v[180:183], v241 offset:8192
    v_add_f32 v2, v2, v156
    v_add_f32 v3, v3, v157
    v_mfma_f32_32x32x16_bf16 v[128:143], v[184:187], v[40:43], v[128:143]
    ds_read_b128 v[184:187], v242 offset:8192
    v_cvt_pk_bf16_f32 v174, v156, v157
    v_add_f32 v2, v2, v158
    v_mfma_f32_32x32x16_bf16 v[128:143], v[188:191], v[44:47], v[128:143]
    ds_read_b128 v[188:191], v243 offset:8192
    v_add_f32 v3, v3, v159
    v_cvt_pk_bf16_f32 v175, v158, v159
    s_waitcnt lgkmcnt(4)
    v_mfma_f32_32x32x16_bf16 v[128:143], v[192:195], v[48:51], v[128:143]
    ds_read_b128 v[192:195], v244 offset:8192
    v_mfma_f32_32x32x16_bf16 v[128:143], v[196:199], v[52:55], v[128:143]
    ds_read_b128 v[196:199], v245 offset:8192
    v_mfma_f32_32x32x16_bf16 v[128:143], v[200:203], v[56:59], v[128:143]
    ds_read_b128 v[200:203], v246 offset:8192
    v_mfma_f32_32x32x16_bf16 v[128:143], v[204:207], v[60:63], v[128:143]
    ds_read_b128 v[204:207], v247 offset:8192
    v_mfma_f32_32x32x16_bf16 v[64:79], v[208:211], v[168:171], v[64:79]
    ds_read_b64_tr_b16 v[208:209], v248
    ds_read_b64_tr_b16 v[210:211], v248 offset:2048
    v_mfma_f32_32x32x16_bf16 v[80:95], v[212:215], v[168:171], v[80:95]
    ds_read_b64_tr_b16 v[212:213], v249
    ds_read_b64_tr_b16 v[214:215], v249 offset:2048
    s_waitcnt lgkmcnt(4)
    v_mfma_f32_32x32x16_bf16 v[96:111], v[216:219], v[168:171], v[96:111]
    ds_read_b64_tr_b16 v[216:217], v250
    ds_read_b64_tr_b16 v[218:219], v250 offset:2048
    s_nop 0
    v_exp_f32 v128, v128
    v_exp_f32 v129, v129
    v_exp_f32 v130, v130
    v_exp_f32 v131, v131
    v_mfma_f32_32x32x16_bf16 v[112:127], v[220:223], v[168:171], v[112:127]
    ds_read_b64_tr_b16 v[220:221], v251
    ds_read_b64_tr_b16 v[222:223], v251 offset:2048
    v_add_f32 v2, v2, v128
    v_add_f32 v3, v3, v129
    v_cvt_pk_bf16_f32 v160, v128, v129
    v_exp_f32 v132, v132
    v_mfma_f32_32x32x16_bf16 v[64:79], v[224:227], v[172:175], v[64:79]
    ds_read_b64_tr_b16 v[224:225], v248 offset:4096
    ds_read_b64_tr_b16 v[226:227], v248 offset:6144
    v_exp_f32 v133, v133
    v_add_f32 v2, v2, v130
    v_add_f32 v3, v3, v131
    s_waitcnt lgkmcnt(6)
    v_mfma_f32_32x32x16_bf16 v[80:95], v[228:231], v[172:175], v[80:95]
    ds_read_b64_tr_b16 v[228:229], v249 offset:4096
    ds_read_b64_tr_b16 v[230:231], v249 offset:6144
    v_cvt_pk_bf16_f32 v161, v130, v131
    v_exp_f32 v134, v134
    v_exp_f32 v135, v135
    v_mfma_f32_32x32x16_bf16 v[96:111], v[232:235], v[172:175], v[96:111]
    ds_read_b64_tr_b16 v[232:233], v250 offset:4096
    ds_read_b64_tr_b16 v[234:235], v250 offset:6144
    v_add_f32 v2, v2, v132
    v_add_f32 v3, v3, v133
    v_cvt_pk_bf16_f32 v162, v132, v133
    v_mfma_f32_32x32x16_bf16 v[112:127], v[236:239], v[172:175], v[112:127]
    ds_read_b64_tr_b16 v[236:237], v251 offset:4096
    ds_read_b64_tr_b16 v[238:239], v251 offset:6144
    v_add_f32 v2, v2, v134
    v_add_f32 v3, v3, v135
    v_cvt_pk_bf16_f32 v163, v134, v135
    s_waitcnt lgkmcnt(6)
    v_mfma_f32_32x32x16_bf16 v[144:159], v[176:179], v[32:35], v[16:31]
    ds_read_b64_tr_b16 v[176:177], v248 offset:8192
    ds_read_b64_tr_b16 v[178:179], v248 offset:10240
    v_exp_f32 v136, v136
    v_exp_f32 v137, v137
    v_exp_f32 v138, v138
    v_mfma_f32_32x32x16_bf16 v[144:159], v[180:183], v[36:39], v[144:159]
    ds_read_b64_tr_b16 v[180:181], v249 offset:8192
    ds_read_b64_tr_b16 v[182:183], v249 offset:10240
    v_exp_f32 v139, v139
    v_add_f32 v2, v2, v136
    v_add_f32 v3, v3, v137
    v_mfma_f32_32x32x16_bf16 v[144:159], v[184:187], v[40:43], v[144:159]
    ds_read_b64_tr_b16 v[184:185], v250 offset:8192
    ds_read_b64_tr_b16 v[186:187], v250 offset:10240
    v_cvt_pk_bf16_f32 v164, v136, v137
    v_exp_f32 v140, v140
    v_exp_f32 v141, v141
    s_waitcnt lgkmcnt(6)
    v_mfma_f32_32x32x16_bf16 v[144:159], v[188:191], v[44:47], v[144:159]
    ds_read_b64_tr_b16 v[188:189], v251 offset:8192
    ds_read_b64_tr_b16 v[190:191], v251 offset:10240
    v_add_f32 v2, v2, v138
    v_add_f32 v3, v3, v139
    v_cvt_pk_bf16_f32 v165, v138, v139
    v_mfma_f32_32x32x16_bf16 v[144:159], v[192:195], v[48:51], v[144:159]
    ds_read_b64_tr_b16 v[192:193], v248 offset:12288
    ds_read_b64_tr_b16 v[194:195], v248 offset:14336
    v_exp_f32 v142, v142
    v_exp_f32 v143, v143
    v_mfma_f32_32x32x16_bf16 v[144:159], v[196:199], v[52:55], v[144:159]
    ds_read_b64_tr_b16 v[196:197], v249 offset:12288
    ds_read_b64_tr_b16 v[198:199], v249 offset:14336
    v_add_f32 v2, v2, v140
    v_add_f32 v3, v3, v141
    s_waitcnt lgkmcnt(6)
    v_mfma_f32_32x32x16_bf16 v[144:159], v[200:203], v[56:59], v[144:159]
    ds_read_b64_tr_b16 v[200:201], v250 offset:12288
    ds_read_b64_tr_b16 v[202:203], v250 offset:14336
    v_cvt_pk_bf16_f32 v166, v140, v141
    v_add_f32 v2, v2, v142
    v_mfma_f32_32x32x16_bf16 v[144:159], v[204:207], v[60:63], v[144:159]
    ds_read_b64_tr_b16 v[204:205], v251 offset:12288
    ds_read_b64_tr_b16 v[206:207], v251 offset:14336
    v_add_f32 v3, v3, v143
    v_cvt_pk_bf16_f32 v167, v142, v143
    s_add_u32 s35, s35, 1
    s_cmp_eq_u32 s35, 3
    s_cselect_b32 s33, s49, s50
    s_cselect_b32 s35, 0, s35
    v_mfma_f32_32x32x16_bf16 v[64:79], v[208:211], v[160:163], v[64:79]
    v_add_u32 v240, s33, v240
    v_add_u32 v241, s33, v241
    v_add_u32 v242, s33, v242
    v_add_u32 v243, s33, v243
    v_add_u32 v244, s33, v244
    v_add_u32 v245, s33, v245
    v_mfma_f32_32x32x16_bf16 v[80:95], v[212:215], v[160:163], v[80:95]
    v_add_u32 v246, s33, v246
    v_add_u32 v247, s33, v247
    v_add_u32 v248, s33, v248
    v_add_u32 v249, s33, v249
    v_add_u32 v250, s33, v250
    v_add_u32 v251, s33, v251
    v_mfma_f32_32x32x16_bf16 v[96:111], v[216:219], v[160:163], v[96:111]
    v_exp_f32 v144, v144
    v_exp_f32 v145, v145
    v_exp_f32 v146, v146
    v_exp_f32 v147, v147
    v_mfma_f32_32x32x16_bf16 v[112:127], v[220:223], v[160:163], v[112:127]
    v_add_f32 v2, v2, v144
    v_add_f32 v3, v3, v145
    v_cvt_pk_bf16_f32 v168, v144, v145
    v_exp_f32 v148, v148
    v_mfma_f32_32x32x16_bf16 v[64:79], v[224:227], v[164:167], v[64:79]
    v_exp_f32 v149, v149
    v_add_f32 v2, v2, v146
    v_add_f32 v3, v3, v147
    v_mfma_f32_32x32x16_bf16 v[80:95], v[228:231], v[164:167], v[80:95]
    v_cvt_pk_bf16_f32 v169, v146, v147
    v_exp_f32 v150, v150
    v_exp_f32 v151, v151
    v_mfma_f32_32x32x16_bf16 v[96:111], v[232:235], v[164:167], v[96:111]
    v_add_f32 v2, v2, v148
    v_add_f32 v3, v3, v149
    v_cvt_pk_bf16_f32 v170, v148, v149
    v_mfma_f32_32x32x16_bf16 v[112:127], v[236:239], v[164:167], v[112:127]
    v_add_f32 v2, v2, v150
    v_add_f32 v3, v3, v151
    v_cvt_pk_bf16_f32 v171, v150, v151
    s_waitcnt lgkmcnt(0)
    s_branch standalone__mha_block_cached__near_ridge_kernel_Aloop
standalone__mha_block_cached__near_ridge_kernel_Aepi:
    s_nop 0
    v_exp_f32 v152, v152
    v_exp_f32 v153, v153
    v_exp_f32 v154, v154
    v_exp_f32 v155, v155
    v_add_f32 v2, v2, v152
    v_add_f32 v3, v3, v153
    v_cvt_pk_bf16_f32 v172, v152, v153
    v_exp_f32 v156, v156
    v_exp_f32 v157, v157
    v_add_f32 v2, v2, v154
    v_add_f32 v3, v3, v155
    v_cvt_pk_bf16_f32 v173, v154, v155
    v_exp_f32 v158, v158
    v_exp_f32 v159, v159
    v_add_f32 v2, v2, v156
    v_add_f32 v3, v3, v157
    v_cvt_pk_bf16_f32 v174, v156, v157
    v_add_f32 v2, v2, v158
    v_add_f32 v3, v3, v159
    v_cvt_pk_bf16_f32 v175, v158, v159
    v_mfma_f32_32x32x16_bf16 v[64:79], v[208:211], v[168:171], v[64:79]
    v_mfma_f32_32x32x16_bf16 v[80:95], v[212:215], v[168:171], v[80:95]
    v_mfma_f32_32x32x16_bf16 v[96:111], v[216:219], v[168:171], v[96:111]
    v_mfma_f32_32x32x16_bf16 v[112:127], v[220:223], v[168:171], v[112:127]
    v_mfma_f32_32x32x16_bf16 v[64:79], v[224:227], v[172:175], v[64:79]
    v_mfma_f32_32x32x16_bf16 v[80:95], v[228:231], v[172:175], v[80:95]
    v_mfma_f32_32x32x16_bf16 v[96:111], v[232:235], v[172:175], v[96:111]
    v_mfma_f32_32x32x16_bf16 v[112:127], v[236:239], v[172:175], v[112:127]
    s_nop 11
    v_add_f32 v2, v2, v3
    v_mov_b32 v4, v2
    s_nop 1
    v_permlane32_swap_b32 v2, v4
    v_add_f32 v2, v2, v4
    s_mov_b32 s33, 0x4e800000
    v_cmp_nlt_f32_e64 vcc, v2, s33
    s_nop 4
    s_cbranch_vccnz standalone__mha_block_cached__near_ridge_kernel_Aslow
standalone__mha_block_cached__near_ridge_kernel_Anorm:
    s_nop 0
    v_rcp_f32 v4, v2
    s_nop 0
    v_mul_f32 v64, v64, v4
    v_mul_f32 v65, v65, v4
    v_mul_f32 v66, v66, v4
    v_mul_f32 v67, v67, v4
    v_mul_f32 v68, v68, v4
    v_mul_f32 v69, v69, v4
    v_mul_f32 v70, v70, v4
    v_mul_f32 v71, v71, v4
    v_cvt_pk_bf16_f32 v128, v64, v65
    v_cvt_pk_bf16_f32 v129, v66, v67
    v_cvt_pk_bf16_f32 v130, v68, v69
    v_cvt_pk_bf16_f32 v131, v70, v71
    v_mul_f32 v72, v72, v4
    v_mul_f32 v73, v73, v4
    v_mul_f32 v74, v74, v4
    v_mul_f32 v75, v75, v4
    v_mul_f32 v76, v76, v4
    v_mul_f32 v77, v77, v4
    v_mul_f32 v78, v78, v4
    v_mul_f32 v79, v79, v4
    v_cvt_pk_bf16_f32 v132, v72, v73
    v_cvt_pk_bf16_f32 v133, v74, v75
    v_cvt_pk_bf16_f32 v134, v76, v77
    v_cvt_pk_bf16_f32 v135, v78, v79
    v_mul_f32 v80, v80, v4
    v_mul_f32 v81, v81, v4
    v_mul_f32 v82, v82, v4
    v_mul_f32 v83, v83, v4
    v_mul_f32 v84, v84, v4
    v_mul_f32 v85, v85, v4
    v_mul_f32 v86, v86, v4
    v_mul_f32 v87, v87, v4
    v_cvt_pk_bf16_f32 v136, v80, v81
    v_cvt_pk_bf16_f32 v137, v82, v83
    v_cvt_pk_bf16_f32 v138, v84, v85
    v_cvt_pk_bf16_f32 v139, v86, v87
    v_mul_f32 v88, v88, v4
    v_mul_f32 v89, v89, v4
    v_mul_f32 v90, v90, v4
    v_mul_f32 v91, v91, v4
    v_mul_f32 v92, v92, v4
    v_mul_f32 v93, v93, v4
    v_mul_f32 v94, v94, v4
    v_mul_f32 v95, v95, v4
    v_cvt_pk_bf16_f32 v140, v88, v89
    v_cvt_pk_bf16_f32 v141, v90, v91
    v_cvt_pk_bf16_f32 v142, v92, v93
    v_cvt_pk_bf16_f32 v143, v94, v95
    v_mul_f32 v96, v96, v4
    v_mul_f32 v97, v97, v4
    v_mul_f32 v98, v98, v4
    v_mul_f32 v99, v99, v4
    v_mul_f32 v100, v100, v4
    v_mul_f32 v101, v101, v4
    v_mul_f32 v102, v102, v4
    v_mul_f32 v103, v103, v4
    v_cvt_pk_bf16_f32 v144, v96, v97
    v_cvt_pk_bf16_f32 v145, v98, v99
    v_cvt_pk_bf16_f32 v146, v100, v101
    v_cvt_pk_bf16_f32 v147, v102, v103
    v_mul_f32 v104, v104, v4
    v_mul_f32 v105, v105, v4
    v_mul_f32 v106, v106, v4
    v_mul_f32 v107, v107, v4
    v_mul_f32 v108, v108, v4
    v_mul_f32 v109, v109, v4
    v_mul_f32 v110, v110, v4
    v_mul_f32 v111, v111, v4
    v_cvt_pk_bf16_f32 v148, v104, v105
    v_cvt_pk_bf16_f32 v149, v106, v107
    v_cvt_pk_bf16_f32 v150, v108, v109
    v_cvt_pk_bf16_f32 v151, v110, v111
    v_mul_f32 v112, v112, v4
    v_mul_f32 v113, v113, v4
    v_mul_f32 v114, v114, v4
    v_mul_f32 v115, v115, v4
    v_mul_f32 v116, v116, v4
    v_mul_f32 v117, v117, v4
    v_mul_f32 v118, v118, v4
    v_mul_f32 v119, v119, v4
    v_cvt_pk_bf16_f32 v152, v112, v113
    v_cvt_pk_bf16_f32 v153, v114, v115
    v_cvt_pk_bf16_f32 v154, v116, v117
    v_cvt_pk_bf16_f32 v155, v118, v119
    v_mul_f32 v120, v120, v4
    v_mul_f32 v121, v121, v4
    v_mul_f32 v122, v122, v4
    v_mul_f32 v123, v123, v4
    v_mul_f32 v124, v124, v4
    v_mul_f32 v125, v125, v4
    v_mul_f32 v126, v126, v4
    v_mul_f32 v127, v127, v4
    v_cvt_pk_bf16_f32 v156, v120, v121
    v_cvt_pk_bf16_f32 v157, v122, v123
    v_cvt_pk_bf16_f32 v158, v124, v125
    v_cvt_pk_bf16_f32 v159, v126, v127
    s_cmp_eq_u32 s46, 1
    s_cbranch_scc1 standalone__mha_block_cached__near_ridge_kernel_Afin
    s_sub_u32 s33, s34, 65536
    buffer_store_dwordx4 v[128:131], v15, s[24:27], s33 offen sc0 sc1
    buffer_store_dwordx4 v[132:135], v15, s[24:27], s33 offen offset:512 sc0 sc1
    buffer_store_dwordx4 v[136:139], v15, s[24:27], s33 offen offset:1024 sc0 sc1
    buffer_store_dwordx4 v[140:143], v15, s[24:27], s33 offen offset:1536 sc0 sc1
    buffer_store_dwordx4 v[144:147], v15, s[24:27], s33 offen offset:2048 sc0 sc1
    buffer_store_dwordx4 v[148:151], v15, s[24:27], s33 offen offset:2560 sc0 sc1
    buffer_store_dwordx4 v[152:155], v15, s[24:27], s33 offen offset:3072 sc0 sc1
    buffer_store_dwordx4 v[156:159], v15, s[24:27], s33 offen offset:3584 sc0 sc1
    s_mov_b32 s46, 1
    s_nop 1
    s_branch standalone__mha_block_cached__near_ridge_kernel_Apair
standalone__mha_block_cached__near_ridge_kernel_Afin:
    buffer_store_dwordx4 v[128:131], v15, s[24:27], s34 offen sc0 sc1
    buffer_store_dwordx4 v[132:135], v15, s[24:27], s34 offen offset:512 sc0 sc1
    buffer_store_dwordx4 v[136:139], v15, s[24:27], s34 offen offset:1024 sc0 sc1
    buffer_store_dwordx4 v[140:143], v15, s[24:27], s34 offen offset:1536 sc0 sc1
    buffer_store_dwordx4 v[144:147], v15, s[24:27], s34 offen offset:2048 sc0 sc1
    buffer_store_dwordx4 v[148:151], v15, s[24:27], s34 offen offset:2560 sc0 sc1
    buffer_store_dwordx4 v[152:155], v15, s[24:27], s34 offen offset:3072 sc0 sc1
    buffer_store_dwordx4 v[156:159], v15, s[24:27], s34 offen offset:3584 sc0 sc1
    s_waitcnt vmcnt(0)
    s_mov_b32 s16, s58
    s_and_b32 s17, s59, 0xffff
    s_mov_b32 s18, 0x100
    s_mov_b32 s19, 0x20000
    v_mov_b32 v228, 0
    v_mov_b32 v231, 1
    s_mov_b64 exec, 1
    ds_add_u32 v228, v231 offset:12
    s_waitcnt lgkmcnt(0)
    s_mov_b64 exec, -1
    s_cmp_lg_u32 s3, 0
    s_cbranch_scc1 standalone__mha_block_cached__near_ridge_kernel_nosigB
standalone__mha_block_cached__near_ridge_kernel_spB:
    ds_read_b32 v229, v228 offset:12
    s_waitcnt lgkmcnt(0)
    v_readfirstlane_b32 s33, v229
    s_nop 3
    s_cmp_ge_u32 s33, 4
    s_cbranch_scc1 standalone__mha_block_cached__near_ridge_kernel_spBd
    s_sleep 1
    s_branch standalone__mha_block_cached__near_ridge_kernel_spB
standalone__mha_block_cached__near_ridge_kernel_spBd:
    s_mov_b64 exec, 1
    s_lshl_b32 s33, s7, 2
    s_add_u32 s33, s33, 128
    buffer_atomic_add v231, v228, s[16:19], s33 offen sc1
    s_mov_b64 exec, -1
standalone__mha_block_cached__near_ridge_kernel_nosigB:
    v_mov_b32 v64, 0
    v_mov_b32 v65, 0
    v_mov_b32 v66, 0
    v_mov_b32 v67, 0
    v_mov_b32 v68, 0
    v_mov_b32 v69, 0
    v_mov_b32 v70, 0
    v_mov_b32 v71, 0
    v_mov_b32 v72, 0
    v_mov_b32 v73, 0
    v_mov_b32 v74, 0
    v_mov_b32 v75, 0
    v_mov_b32 v76, 0
    v_mov_b32 v77, 0
    v_mov_b32 v78, 0
    v_mov_b32 v79, 0
    v_mov_b32 v80, 0
    v_mov_b32 v81, 0
    v_mov_b32 v82, 0
    v_mov_b32 v83, 0
    v_mov_b32 v84, 0
    v_mov_b32 v85, 0
    v_mov_b32 v86, 0
    v_mov_b32 v87, 0
    v_mov_b32 v88, 0
    v_mov_b32 v89, 0
    v_mov_b32 v90, 0
    v_mov_b32 v91, 0
    v_mov_b32 v92, 0
    v_mov_b32 v93, 0
    v_mov_b32 v94, 0
    v_mov_b32 v95, 0
    v_mov_b32 v96, 0
    v_mov_b32 v97, 0
    v_mov_b32 v98, 0
    v_mov_b32 v99, 0
    v_mov_b32 v100, 0
    v_mov_b32 v101, 0
    v_mov_b32 v102, 0
    v_mov_b32 v103, 0
    v_mov_b32 v104, 0
    v_mov_b32 v105, 0
    v_mov_b32 v106, 0
    v_mov_b32 v107, 0
    v_mov_b32 v108, 0
    v_mov_b32 v109, 0
    v_mov_b32 v110, 0
    v_mov_b32 v111, 0
    v_mov_b32 v112, 0
    v_mov_b32 v113, 0
    v_mov_b32 v114, 0
    v_mov_b32 v115, 0
    v_mov_b32 v116, 0
    v_mov_b32 v117, 0
    v_mov_b32 v118, 0
    v_mov_b32 v119, 0
    v_mov_b32 v120, 0
    v_mov_b32 v121, 0
    v_mov_b32 v122, 0
    v_mov_b32 v123, 0
    v_mov_b32 v124, 0
    v_mov_b32 v125, 0
    v_mov_b32 v126, 0
    v_mov_b32 v127, 0
    v_mov_b32 v128, 0
    v_mov_b32 v129, 0
    v_mov_b32 v130, 0
    v_mov_b32 v131, 0
    v_mov_b32 v132, 0
    v_mov_b32 v133, 0
    v_mov_b32 v134, 0
    v_mov_b32 v135, 0
    v_mov_b32 v136, 0
    v_mov_b32 v137, 0
    v_mov_b32 v138, 0
    v_mov_b32 v139, 0
    v_mov_b32 v140, 0
    v_mov_b32 v141, 0
    v_mov_b32 v142, 0
    v_mov_b32 v143, 0
standalone__mha_block_cached__near_ridge_kernel_Tail:
    s_nop 0
    s_mov_b32 s24, s44
    s_and_b32 s25, s45, 0xffff
    s_mov_b32 s26, 0x2000000
    s_mov_b32 s27, 0x20000
    s_mov_b32 s20, s56
    s_and_b32 s21, s57, 0xffff
    s_mov_b32 s22, 0x280000
    s_mov_b32 s23, 0x20000
    s_and_b32 s4, s2, 7
    s_lshr_b32 s5, s2, 3
    s_lshr_b32 s33, s4, 1
    s_lshl_b32 s33, s33, 3
    s_lshr_b32 s35, s5, 2
    s_add_u32 s33, s33, s35
    s_and_b32 s4, s4, 1
    s_lshl_b32 s4, s4, 2
    s_and_b32 s5, s5, 3
    s_add_u32 s5, s4, s5
    s_mov_b32 s4, s33
    v_mbcnt_lo_u32_b32 v2, -1, 0
    v_mbcnt_hi_u32_b32 v2, -1, v2
    v_mov_b32 v0, v2
    v_lshlrev_b32 v2, 4, v2
    v_add_u32 v3, 4096, v2
    v_mov_b32 v6, 0
    v_add_u32 v4, 8192, v2
    v_add_u32 v5, 12288, v2
    s_cmp_ge_u32 s3, 4
    s_cbranch_scc1 standalone__mha_block_cached__near_ridge_kernel_TVP
    s_cmp_lg_u32 s3, 4
    s_cbranch_scc1 standalone__mha_block_cached__near_ridge_kernel_g0o
    s_lshr_b32 s51, s4, 1
    s_lshl_b32 s51, s51, 2
    s_add_u32 s51, s51, 64
    v_cmp_eq_u32 vcc, 0, v0
    v_mov_b32 v7, s51
    s_nop 1
    v_cndmask_b32 v7, v7, v6, vcc
    s_mov_b32 s63, 0
standalone__mha_block_cached__near_ridge_kernel_g0p:
    s_mov_b64 exec, 3
    buffer_load_dword v8, v7, s[16:19], 0 offen sc1
    s_mov_b64 exec, -1
    s_waitcnt vmcnt(0)
    v_readlane_b32 s33, v8, 0
    v_readlane_b32 s35, v8, 1
    s_nop 3
    s_cmp_ge_u32 s33, 256
    s_cselect_b32 s61, 1, 0
    s_cmp_ge_u32 s35, 16
    s_cselect_b32 s61, s61, 0
    s_cmp_lg_u32 s61, 0
    s_cbranch_scc1 standalone__mha_block_cached__near_ridge_kernel_g0s
    s_sleep 16
    s_add_u32 s63, s63, 1
    s_cmp_lt_u32 s63, 0x80000
    s_cbranch_scc1 standalone__mha_block_cached__near_ridge_kernel_g0p
standalone__mha_block_cached__near_ridge_kernel_g0s:
    v_mov_b32 v8, 1
    ds_write_b32 v6, v8 offset:8
    s_waitcnt lgkmcnt(0)
    s_branch standalone__mha_block_cached__near_ridge_kernel_g0d
standalone__mha_block_cached__near_ridge_kernel_g0o:
    s_mov_b32 s63, 0
standalone__mha_block_cached__near_ridge_kernel_g0oo:
    ds_read_b32 v8, v6 offset:8
    s_waitcnt lgkmcnt(0)
    v_readfirstlane_b32 s61, v8
    s_nop 3
    s_cmp_lg_u32 s61, 0
    s_cbranch_scc1 standalone__mha_block_cached__near_ridge_kernel_g0d
    s_sleep 2
    s_add_u32 s63, s63, 1
    s_cmp_lt_u32 s63, 0x800000
    s_cbranch_scc1 standalone__mha_block_cached__near_ridge_kernel_g0oo
standalone__mha_block_cached__near_ridge_kernel_g0d:
    s_mul_i32 s62, s3, 6
    s_add_u32 s62, s62, 40
    s_lshl_b32 s33, s4, 9
    s_add_u32 s33, s33, s62
    s_lshl_b32 s33, s33, 10
    s_add_u32 s36, s33, 0
    s_add_u32 s37, s33, 131072
    s_add_u32 s38, s33, 262144
    s_add_u32 s39, s33, 393216
    s_mul_i32 s33, s5, 640
    s_add_u32 s33, s33, s62
    s_lshl_b32 s33, s33, 10
    s_add_u32 s40, s33, 25165824
    s_add_u32 s41, s33, 25296896
    s_add_u32 s42, s33, 25427968
    s_add_u32 s43, s33, 25559040
    s_add_u32 s46, s33, 25690112
    buffer_load_dwordx4 v[144:147], v2, s[24:27], s40 offen sc1
    buffer_load_dwordx4 v[148:151], v2, s[24:27], s41 offen sc1
    buffer_load_dwordx4 v[152:155], v2, s[24:27], s42 offen sc1
    buffer_load_dwordx4 v[156:159], v2, s[24:27], s43 offen sc1
    buffer_load_dwordx4 v[160:163], v2, s[24:27], s46 offen sc1
    buffer_load_dwordx4 v[164:167], v2, s[24:27], s36 offen sc1
    buffer_load_dwordx4 v[168:171], v2, s[24:27], s37 offen sc1
    buffer_load_dwordx4 v[172:175], v2, s[24:27], s38 offen sc1
    buffer_load_dwordx4 v[176:179], v2, s[24:27], s39 offen sc1
    buffer_load_dwordx4 v[180:183], v2, s[24:27], s40 offen offset:1024 sc1
    buffer_load_dwordx4 v[184:187], v2, s[24:27], s41 offen offset:1024 sc1
    buffer_load_dwordx4 v[188:191], v2, s[24:27], s42 offen offset:1024 sc1
    buffer_load_dwordx4 v[192:195], v2, s[24:27], s43 offen offset:1024 sc1
    buffer_load_dwordx4 v[196:199], v2, s[24:27], s46 offen offset:1024 sc1
    buffer_load_dwordx4 v[200:203], v2, s[24:27], s36 offen offset:1024 sc1
    buffer_load_dwordx4 v[204:207], v2, s[24:27], s37 offen offset:1024 sc1
    buffer_load_dwordx4 v[208:211], v2, s[24:27], s38 offen offset:1024 sc1
    buffer_load_dwordx4 v[212:215], v2, s[24:27], s39 offen offset:1024 sc1
    buffer_load_dwordx4 v[216:219], v2, s[24:27], s40 offen offset:2048 sc1
    buffer_load_dwordx4 v[220:223], v2, s[24:27], s41 offen offset:2048 sc1
    buffer_load_dwordx4 v[224:227], v2, s[24:27], s42 offen offset:2048 sc1
    buffer_load_dwordx4 v[228:231], v2, s[24:27], s43 offen offset:2048 sc1
    buffer_load_dwordx4 v[232:235], v2, s[24:27], s46 offen offset:2048 sc1
    buffer_load_dwordx4 v[236:239], v2, s[24:27], s36 offen offset:2048 sc1
    buffer_load_dwordx4 v[240:243], v2, s[24:27], s37 offen offset:2048 sc1
    buffer_load_dwordx4 v[244:247], v2, s[24:27], s38 offen offset:2048 sc1
    buffer_load_dwordx4 v[248:251], v2, s[24:27], s39 offen offset:2048 sc1
    s_waitcnt vmcnt(21)
    v_mfma_f32_16x16x32_bf16 v[64:67], v[144:147], v[164:167], v[64:67]
    s_waitcnt vmcnt(20)
    v_mfma_f32_16x16x32_bf16 v[68:71], v[144:147], v[168:171], v[68:71]
    s_waitcnt vmcnt(19)
    v_mfma_f32_16x16x32_bf16 v[72:75], v[144:147], v[172:175], v[72:75]
    s_waitcnt vmcnt(18)
    v_mfma_f32_16x16x32_bf16 v[76:79], v[144:147], v[176:179], v[76:79]
    v_mfma_f32_16x16x32_bf16 v[80:83], v[148:151], v[164:167], v[80:83]
    v_mfma_f32_16x16x32_bf16 v[84:87], v[148:151], v[168:171], v[84:87]
    v_mfma_f32_16x16x32_bf16 v[88:91], v[148:151], v[172:175], v[88:91]
    v_mfma_f32_16x16x32_bf16 v[92:95], v[148:151], v[176:179], v[92:95]
    v_mfma_f32_16x16x32_bf16 v[96:99], v[152:155], v[164:167], v[96:99]
    v_mfma_f32_16x16x32_bf16 v[100:103], v[152:155], v[168:171], v[100:103]
    v_mfma_f32_16x16x32_bf16 v[104:107], v[152:155], v[172:175], v[104:107]
    v_mfma_f32_16x16x32_bf16 v[108:111], v[152:155], v[176:179], v[108:111]
    v_mfma_f32_16x16x32_bf16 v[112:115], v[156:159], v[164:167], v[112:115]
    v_mfma_f32_16x16x32_bf16 v[116:119], v[156:159], v[168:171], v[116:119]
    v_mfma_f32_16x16x32_bf16 v[120:123], v[156:159], v[172:175], v[120:123]
    v_mfma_f32_16x16x32_bf16 v[124:127], v[156:159], v[176:179], v[124:127]
    v_mfma_f32_16x16x32_bf16 v[128:131], v[160:163], v[164:167], v[128:131]
    v_mfma_f32_16x16x32_bf16 v[132:135], v[160:163], v[168:171], v[132:135]
    v_mfma_f32_16x16x32_bf16 v[136:139], v[160:163], v[172:175], v[136:139]
    v_mfma_f32_16x16x32_bf16 v[140:143], v[160:163], v[176:179], v[140:143]
    buffer_load_dwordx4 v[144:147], v2, s[24:27], s40 offen offset:3072 sc1
    buffer_load_dwordx4 v[148:151], v2, s[24:27], s41 offen offset:3072 sc1
    buffer_load_dwordx4 v[152:155], v2, s[24:27], s42 offen offset:3072 sc1
    buffer_load_dwordx4 v[156:159], v2, s[24:27], s43 offen offset:3072 sc1
    buffer_load_dwordx4 v[160:163], v2, s[24:27], s46 offen offset:3072 sc1
    buffer_load_dwordx4 v[164:167], v2, s[24:27], s36 offen offset:3072 sc1
    buffer_load_dwordx4 v[168:171], v2, s[24:27], s37 offen offset:3072 sc1
    buffer_load_dwordx4 v[172:175], v2, s[24:27], s38 offen offset:3072 sc1
    buffer_load_dwordx4 v[176:179], v2, s[24:27], s39 offen offset:3072 sc1
    s_waitcnt vmcnt(21)
    v_mfma_f32_16x16x32_bf16 v[64:67], v[180:183], v[200:203], v[64:67]
    s_waitcnt vmcnt(20)
    v_mfma_f32_16x16x32_bf16 v[68:71], v[180:183], v[204:207], v[68:71]
    s_waitcnt vmcnt(19)
    v_mfma_f32_16x16x32_bf16 v[72:75], v[180:183], v[208:211], v[72:75]
    s_waitcnt vmcnt(18)
    v_mfma_f32_16x16x32_bf16 v[76:79], v[180:183], v[212:215], v[76:79]
    v_mfma_f32_16x16x32_bf16 v[80:83], v[184:187], v[200:203], v[80:83]
    v_mfma_f32_16x16x32_bf16 v[84:87], v[184:187], v[204:207], v[84:87]
    v_mfma_f32_16x16x32_bf16 v[88:91], v[184:187], v[208:211], v[88:91]
    v_mfma_f32_16x16x32_bf16 v[92:95], v[184:187], v[212:215], v[92:95]
    v_mfma_f32_16x16x32_bf16 v[96:99], v[188:191], v[200:203], v[96:99]
    v_mfma_f32_16x16x32_bf16 v[100:103], v[188:191], v[204:207], v[100:103]
    v_mfma_f32_16x16x32_bf16 v[104:107], v[188:191], v[208:211], v[104:107]
    v_mfma_f32_16x16x32_bf16 v[108:111], v[188:191], v[212:215], v[108:111]
    v_mfma_f32_16x16x32_bf16 v[112:115], v[192:195], v[200:203], v[112:115]
    v_mfma_f32_16x16x32_bf16 v[116:119], v[192:195], v[204:207], v[116:119]
    v_mfma_f32_16x16x32_bf16 v[120:123], v[192:195], v[208:211], v[120:123]
    v_mfma_f32_16x16x32_bf16 v[124:127], v[192:195], v[212:215], v[124:127]
    v_mfma_f32_16x16x32_bf16 v[128:131], v[196:199], v[200:203], v[128:131]
    v_mfma_f32_16x16x32_bf16 v[132:135], v[196:199], v[204:207], v[132:135]
    v_mfma_f32_16x16x32_bf16 v[136:139], v[196:199], v[208:211], v[136:139]
    v_mfma_f32_16x16x32_bf16 v[140:143], v[196:199], v[212:215], v[140:143]
    buffer_load_dwordx4 v[180:183], v3, s[24:27], s40 offen sc1
    buffer_load_dwordx4 v[184:187], v3, s[24:27], s41 offen sc1
    buffer_load_dwordx4 v[188:191], v3, s[24:27], s42 offen sc1
    buffer_load_dwordx4 v[192:195], v3, s[24:27], s43 offen sc1
    buffer_load_dwordx4 v[196:199], v3, s[24:27], s46 offen sc1
    buffer_load_dwordx4 v[200:203], v3, s[24:27], s36 offen sc1
    buffer_load_dwordx4 v[204:207], v3, s[24:27], s37 offen sc1
    buffer_load_dwordx4 v[208:211], v3, s[24:27], s38 offen sc1
    buffer_load_dwordx4 v[212:215], v3, s[24:27], s39 offen sc1
    s_waitcnt vmcnt(21)
    v_mfma_f32_16x16x32_bf16 v[64:67], v[216:219], v[236:239], v[64:67]
    s_waitcnt vmcnt(20)
    v_mfma_f32_16x16x32_bf16 v[68:71], v[216:219], v[240:243], v[68:71]
    s_waitcnt vmcnt(19)
    v_mfma_f32_16x16x32_bf16 v[72:75], v[216:219], v[244:247], v[72:75]
    s_waitcnt vmcnt(18)
    v_mfma_f32_16x16x32_bf16 v[76:79], v[216:219], v[248:251], v[76:79]
    v_mfma_f32_16x16x32_bf16 v[80:83], v[220:223], v[236:239], v[80:83]
    v_mfma_f32_16x16x32_bf16 v[84:87], v[220:223], v[240:243], v[84:87]
    v_mfma_f32_16x16x32_bf16 v[88:91], v[220:223], v[244:247], v[88:91]
    v_mfma_f32_16x16x32_bf16 v[92:95], v[220:223], v[248:251], v[92:95]
    v_mfma_f32_16x16x32_bf16 v[96:99], v[224:227], v[236:239], v[96:99]
    v_mfma_f32_16x16x32_bf16 v[100:103], v[224:227], v[240:243], v[100:103]
    v_mfma_f32_16x16x32_bf16 v[104:107], v[224:227], v[244:247], v[104:107]
    v_mfma_f32_16x16x32_bf16 v[108:111], v[224:227], v[248:251], v[108:111]
    v_mfma_f32_16x16x32_bf16 v[112:115], v[228:231], v[236:239], v[112:115]
    v_mfma_f32_16x16x32_bf16 v[116:119], v[228:231], v[240:243], v[116:119]
    v_mfma_f32_16x16x32_bf16 v[120:123], v[228:231], v[244:247], v[120:123]
    v_mfma_f32_16x16x32_bf16 v[124:127], v[228:231], v[248:251], v[124:127]
    v_mfma_f32_16x16x32_bf16 v[128:131], v[232:235], v[236:239], v[128:131]
    v_mfma_f32_16x16x32_bf16 v[132:135], v[232:235], v[240:243], v[132:135]
    v_mfma_f32_16x16x32_bf16 v[136:139], v[232:235], v[244:247], v[136:139]
    v_mfma_f32_16x16x32_bf16 v[140:143], v[232:235], v[248:251], v[140:143]
    buffer_load_dwordx4 v[216:219], v3, s[24:27], s40 offen offset:1024 sc1
    buffer_load_dwordx4 v[220:223], v3, s[24:27], s41 offen offset:1024 sc1
    buffer_load_dwordx4 v[224:227], v3, s[24:27], s42 offen offset:1024 sc1
    buffer_load_dwordx4 v[228:231], v3, s[24:27], s43 offen offset:1024 sc1
    buffer_load_dwordx4 v[232:235], v3, s[24:27], s46 offen offset:1024 sc1
    buffer_load_dwordx4 v[236:239], v3, s[24:27], s36 offen offset:1024 sc1
    buffer_load_dwordx4 v[240:243], v3, s[24:27], s37 offen offset:1024 sc1
    buffer_load_dwordx4 v[244:247], v3, s[24:27], s38 offen offset:1024 sc1
    buffer_load_dwordx4 v[248:251], v3, s[24:27], s39 offen offset:1024 sc1
    s_waitcnt vmcnt(21)
    v_mfma_f32_16x16x32_bf16 v[64:67], v[144:147], v[164:167], v[64:67]
    s_waitcnt vmcnt(20)
    v_mfma_f32_16x16x32_bf16 v[68:71], v[144:147], v[168:171], v[68:71]
    s_waitcnt vmcnt(19)
    v_mfma_f32_16x16x32_bf16 v[72:75], v[144:147], v[172:175], v[72:75]
    s_waitcnt vmcnt(18)
    v_mfma_f32_16x16x32_bf16 v[76:79], v[144:147], v[176:179], v[76:79]
    v_mfma_f32_16x16x32_bf16 v[80:83], v[148:151], v[164:167], v[80:83]
    v_mfma_f32_16x16x32_bf16 v[84:87], v[148:151], v[168:171], v[84:87]
    v_mfma_f32_16x16x32_bf16 v[88:91], v[148:151], v[172:175], v[88:91]
    v_mfma_f32_16x16x32_bf16 v[92:95], v[148:151], v[176:179], v[92:95]
    v_mfma_f32_16x16x32_bf16 v[96:99], v[152:155], v[164:167], v[96:99]
    v_mfma_f32_16x16x32_bf16 v[100:103], v[152:155], v[168:171], v[100:103]
    v_mfma_f32_16x16x32_bf16 v[104:107], v[152:155], v[172:175], v[104:107]
    v_mfma_f32_16x16x32_bf16 v[108:111], v[152:155], v[176:179], v[108:111]
    v_mfma_f32_16x16x32_bf16 v[112:115], v[156:159], v[164:167], v[112:115]
    v_mfma_f32_16x16x32_bf16 v[116:119], v[156:159], v[168:171], v[116:119]
    v_mfma_f32_16x16x32_bf16 v[120:123], v[156:159], v[172:175], v[120:123]
    v_mfma_f32_16x16x32_bf16 v[124:127], v[156:159], v[176:179], v[124:127]
    v_mfma_f32_16x16x32_bf16 v[128:131], v[160:163], v[164:167], v[128:131]
    v_mfma_f32_16x16x32_bf16 v[132:135], v[160:163], v[168:171], v[132:135]
    v_mfma_f32_16x16x32_bf16 v[136:139], v[160:163], v[172:175], v[136:139]
    v_mfma_f32_16x16x32_bf16 v[140:143], v[160:163], v[176:179], v[140:143]
    s_cmp_lg_u32 s3, 4
    s_cbranch_scc1 standalone__mha_block_cached__near_ridge_kernel_g1o
    s_lshr_b32 s51, s4, 1
    s_lshl_b32 s51, s51, 2
    s_add_u32 s51, s51, 128
    v_cmp_eq_u32 vcc, 0, v0
    v_mov_b32 v7, s51
    s_nop 1
    v_cndmask_b32 v7, v7, v6, vcc
    s_mov_b32 s63, 0
standalone__mha_block_cached__near_ridge_kernel_g1p:
    s_mov_b64 exec, 3
    buffer_load_dword v8, v7, s[16:19], 0 offen sc1
    s_mov_b64 exec, -1
    s_waitcnt vmcnt(0)
    v_readlane_b32 s33, v8, 0
    v_readlane_b32 s35, v8, 1
    s_nop 3
    s_cmp_ge_u32 s33, 256
    s_cselect_b32 s61, 1, 0
    s_cmp_ge_u32 s35, 16
    s_cselect_b32 s61, s61, 0
    s_cmp_lg_u32 s61, 0
    s_cbranch_scc1 standalone__mha_block_cached__near_ridge_kernel_g1s
    s_sleep 16
    s_add_u32 s63, s63, 1
    s_cmp_lt_u32 s63, 0x80000
    s_cbranch_scc1 standalone__mha_block_cached__near_ridge_kernel_g1p
standalone__mha_block_cached__near_ridge_kernel_g1s:
    v_mov_b32 v8, 1
    ds_write_b32 v6, v8 offset:4
    s_waitcnt lgkmcnt(0)
    s_branch standalone__mha_block_cached__near_ridge_kernel_g1d
standalone__mha_block_cached__near_ridge_kernel_g1o:
    s_mov_b32 s63, 0
standalone__mha_block_cached__near_ridge_kernel_g1oo:
    ds_read_b32 v8, v6 offset:4
    s_waitcnt lgkmcnt(0)
    v_readfirstlane_b32 s61, v8
    s_nop 3
    s_cmp_lg_u32 s61, 0
    s_cbranch_scc1 standalone__mha_block_cached__near_ridge_kernel_g1d
    s_sleep 2
    s_add_u32 s63, s63, 1
    s_cmp_lt_u32 s63, 0x800000
    s_cbranch_scc1 standalone__mha_block_cached__near_ridge_kernel_g1oo
standalone__mha_block_cached__near_ridge_kernel_g1d:
    s_lshl_b32 s62, s3, 3
    s_add_u32 s62, s62, 64
    s_lshl_b32 s33, s4, 9
    s_add_u32 s33, s33, s62
    s_lshl_b32 s33, s33, 10
    s_add_u32 s36, s33, 0
    s_add_u32 s37, s33, 131072
    s_add_u32 s38, s33, 262144
    s_add_u32 s39, s33, 393216
    s_mul_i32 s33, s5, 640
    s_add_u32 s33, s33, s62
    s_lshl_b32 s33, s33, 10
    s_add_u32 s40, s33, 25165824
    s_add_u32 s41, s33, 25296896
    s_add_u32 s42, s33, 25427968
    s_add_u32 s43, s33, 25559040
    s_add_u32 s46, s33, 25690112
    buffer_load_dwordx4 v[144:147], v2, s[24:27], s40 offen sc1
    buffer_load_dwordx4 v[148:151], v2, s[24:27], s41 offen sc1
    buffer_load_dwordx4 v[152:155], v2, s[24:27], s42 offen sc1
    buffer_load_dwordx4 v[156:159], v2, s[24:27], s43 offen sc1
    buffer_load_dwordx4 v[160:163], v2, s[24:27], s46 offen sc1
    buffer_load_dwordx4 v[164:167], v2, s[24:27], s36 offen sc1
    buffer_load_dwordx4 v[168:171], v2, s[24:27], s37 offen sc1
    buffer_load_dwordx4 v[172:175], v2, s[24:27], s38 offen sc1
    buffer_load_dwordx4 v[176:179], v2, s[24:27], s39 offen sc1
    s_waitcnt vmcnt(21)
    v_mfma_f32_16x16x32_bf16 v[64:67], v[180:183], v[200:203], v[64:67]
    s_waitcnt vmcnt(20)
    v_mfma_f32_16x16x32_bf16 v[68:71], v[180:183], v[204:207], v[68:71]
    s_waitcnt vmcnt(19)
    v_mfma_f32_16x16x32_bf16 v[72:75], v[180:183], v[208:211], v[72:75]
    s_waitcnt vmcnt(18)
    v_mfma_f32_16x16x32_bf16 v[76:79], v[180:183], v[212:215], v[76:79]
    v_mfma_f32_16x16x32_bf16 v[80:83], v[184:187], v[200:203], v[80:83]
    v_mfma_f32_16x16x32_bf16 v[84:87], v[184:187], v[204:207], v[84:87]
    v_mfma_f32_16x16x32_bf16 v[88:91], v[184:187], v[208:211], v[88:91]
    v_mfma_f32_16x16x32_bf16 v[92:95], v[184:187], v[212:215], v[92:95]
    v_mfma_f32_16x16x32_bf16 v[96:99], v[188:191], v[200:203], v[96:99]
    v_mfma_f32_16x16x32_bf16 v[100:103], v[188:191], v[204:207], v[100:103]
    v_mfma_f32_16x16x32_bf16 v[104:107], v[188:191], v[208:211], v[104:107]
    v_mfma_f32_16x16x32_bf16 v[108:111], v[188:191], v[212:215], v[108:111]
    v_mfma_f32_16x16x32_bf16 v[112:115], v[192:195], v[200:203], v[112:115]
    v_mfma_f32_16x16x32_bf16 v[116:119], v[192:195], v[204:207], v[116:119]
    v_mfma_f32_16x16x32_bf16 v[120:123], v[192:195], v[208:211], v[120:123]
    v_mfma_f32_16x16x32_bf16 v[124:127], v[192:195], v[212:215], v[124:127]
    v_mfma_f32_16x16x32_bf16 v[128:131], v[196:199], v[200:203], v[128:131]
    v_mfma_f32_16x16x32_bf16 v[132:135], v[196:199], v[204:207], v[132:135]
    v_mfma_f32_16x16x32_bf16 v[136:139], v[196:199], v[208:211], v[136:139]
    v_mfma_f32_16x16x32_bf16 v[140:143], v[196:199], v[212:215], v[140:143]
    buffer_load_dwordx4 v[180:183], v2, s[24:27], s40 offen offset:1024 sc1
    buffer_load_dwordx4 v[184:187], v2, s[24:27], s41 offen offset:1024 sc1
    buffer_load_dwordx4 v[188:191], v2, s[24:27], s42 offen offset:1024 sc1
    buffer_load_dwordx4 v[192:195], v2, s[24:27], s43 offen offset:1024 sc1
    buffer_load_dwordx4 v[196:199], v2, s[24:27], s46 offen offset:1024 sc1
    buffer_load_dwordx4 v[200:203], v2, s[24:27], s36 offen offset:1024 sc1
    buffer_load_dwordx4 v[204:207], v2, s[24:27], s37 offen offset:1024 sc1
    buffer_load_dwordx4 v[208:211], v2, s[24:27], s38 offen offset:1024 sc1
    buffer_load_dwordx4 v[212:215], v2, s[24:27], s39 offen offset:1024 sc1
    s_waitcnt vmcnt(21)
    v_mfma_f32_16x16x32_bf16 v[64:67], v[216:219], v[236:239], v[64:67]
    s_waitcnt vmcnt(20)
    v_mfma_f32_16x16x32_bf16 v[68:71], v[216:219], v[240:243], v[68:71]
    s_waitcnt vmcnt(19)
    v_mfma_f32_16x16x32_bf16 v[72:75], v[216:219], v[244:247], v[72:75]
    s_waitcnt vmcnt(18)
    v_mfma_f32_16x16x32_bf16 v[76:79], v[216:219], v[248:251], v[76:79]
    v_mfma_f32_16x16x32_bf16 v[80:83], v[220:223], v[236:239], v[80:83]
    v_mfma_f32_16x16x32_bf16 v[84:87], v[220:223], v[240:243], v[84:87]
    v_mfma_f32_16x16x32_bf16 v[88:91], v[220:223], v[244:247], v[88:91]
    v_mfma_f32_16x16x32_bf16 v[92:95], v[220:223], v[248:251], v[92:95]
    v_mfma_f32_16x16x32_bf16 v[96:99], v[224:227], v[236:239], v[96:99]
    v_mfma_f32_16x16x32_bf16 v[100:103], v[224:227], v[240:243], v[100:103]
    v_mfma_f32_16x16x32_bf16 v[104:107], v[224:227], v[244:247], v[104:107]
    v_mfma_f32_16x16x32_bf16 v[108:111], v[224:227], v[248:251], v[108:111]
    v_mfma_f32_16x16x32_bf16 v[112:115], v[228:231], v[236:239], v[112:115]
    v_mfma_f32_16x16x32_bf16 v[116:119], v[228:231], v[240:243], v[116:119]
    v_mfma_f32_16x16x32_bf16 v[120:123], v[228:231], v[244:247], v[120:123]
    v_mfma_f32_16x16x32_bf16 v[124:127], v[228:231], v[248:251], v[124:127]
    v_mfma_f32_16x16x32_bf16 v[128:131], v[232:235], v[236:239], v[128:131]
    v_mfma_f32_16x16x32_bf16 v[132:135], v[232:235], v[240:243], v[132:135]
    v_mfma_f32_16x16x32_bf16 v[136:139], v[232:235], v[244:247], v[136:139]
    v_mfma_f32_16x16x32_bf16 v[140:143], v[232:235], v[248:251], v[140:143]
    buffer_load_dwordx4 v[216:219], v2, s[24:27], s40 offen offset:2048 sc1
    buffer_load_dwordx4 v[220:223], v2, s[24:27], s41 offen offset:2048 sc1
    buffer_load_dwordx4 v[224:227], v2, s[24:27], s42 offen offset:2048 sc1
    buffer_load_dwordx4 v[228:231], v2, s[24:27], s43 offen offset:2048 sc1
    buffer_load_dwordx4 v[232:235], v2, s[24:27], s46 offen offset:2048 sc1
    buffer_load_dwordx4 v[236:239], v2, s[24:27], s36 offen offset:2048 sc1
    buffer_load_dwordx4 v[240:243], v2, s[24:27], s37 offen offset:2048 sc1
    buffer_load_dwordx4 v[244:247], v2, s[24:27], s38 offen offset:2048 sc1
    buffer_load_dwordx4 v[248:251], v2, s[24:27], s39 offen offset:2048 sc1
    s_waitcnt vmcnt(21)
    v_mfma_f32_16x16x32_bf16 v[64:67], v[144:147], v[164:167], v[64:67]
    s_waitcnt vmcnt(20)
    v_mfma_f32_16x16x32_bf16 v[68:71], v[144:147], v[168:171], v[68:71]
    s_waitcnt vmcnt(19)
    v_mfma_f32_16x16x32_bf16 v[72:75], v[144:147], v[172:175], v[72:75]
    s_waitcnt vmcnt(18)
    v_mfma_f32_16x16x32_bf16 v[76:79], v[144:147], v[176:179], v[76:79]
    v_mfma_f32_16x16x32_bf16 v[80:83], v[148:151], v[164:167], v[80:83]
    v_mfma_f32_16x16x32_bf16 v[84:87], v[148:151], v[168:171], v[84:87]
    v_mfma_f32_16x16x32_bf16 v[88:91], v[148:151], v[172:175], v[88:91]
    v_mfma_f32_16x16x32_bf16 v[92:95], v[148:151], v[176:179], v[92:95]
    v_mfma_f32_16x16x32_bf16 v[96:99], v[152:155], v[164:167], v[96:99]
    v_mfma_f32_16x16x32_bf16 v[100:103], v[152:155], v[168:171], v[100:103]
    v_mfma_f32_16x16x32_bf16 v[104:107], v[152:155], v[172:175], v[104:107]
    v_mfma_f32_16x16x32_bf16 v[108:111], v[152:155], v[176:179], v[108:111]
    v_mfma_f32_16x16x32_bf16 v[112:115], v[156:159], v[164:167], v[112:115]
    v_mfma_f32_16x16x32_bf16 v[116:119], v[156:159], v[168:171], v[116:119]
    v_mfma_f32_16x16x32_bf16 v[120:123], v[156:159], v[172:175], v[120:123]
    v_mfma_f32_16x16x32_bf16 v[124:127], v[156:159], v[176:179], v[124:127]
    v_mfma_f32_16x16x32_bf16 v[128:131], v[160:163], v[164:167], v[128:131]
    v_mfma_f32_16x16x32_bf16 v[132:135], v[160:163], v[168:171], v[132:135]
    v_mfma_f32_16x16x32_bf16 v[136:139], v[160:163], v[172:175], v[136:139]
    v_mfma_f32_16x16x32_bf16 v[140:143], v[160:163], v[176:179], v[140:143]
    buffer_load_dwordx4 v[144:147], v2, s[24:27], s40 offen offset:3072 sc1
    buffer_load_dwordx4 v[148:151], v2, s[24:27], s41 offen offset:3072 sc1
    buffer_load_dwordx4 v[152:155], v2, s[24:27], s42 offen offset:3072 sc1
    buffer_load_dwordx4 v[156:159], v2, s[24:27], s43 offen offset:3072 sc1
    buffer_load_dwordx4 v[160:163], v2, s[24:27], s46 offen offset:3072 sc1
    buffer_load_dwordx4 v[164:167], v2, s[24:27], s36 offen offset:3072 sc1
    buffer_load_dwordx4 v[168:171], v2, s[24:27], s37 offen offset:3072 sc1
    buffer_load_dwordx4 v[172:175], v2, s[24:27], s38 offen offset:3072 sc1
    buffer_load_dwordx4 v[176:179], v2, s[24:27], s39 offen offset:3072 sc1
    s_waitcnt vmcnt(21)
    v_mfma_f32_16x16x32_bf16 v[64:67], v[180:183], v[200:203], v[64:67]
    s_waitcnt vmcnt(20)
    v_mfma_f32_16x16x32_bf16 v[68:71], v[180:183], v[204:207], v[68:71]
    s_waitcnt vmcnt(19)
    v_mfma_f32_16x16x32_bf16 v[72:75], v[180:183], v[208:211], v[72:75]
    s_waitcnt vmcnt(18)
    v_mfma_f32_16x16x32_bf16 v[76:79], v[180:183], v[212:215], v[76:79]
    v_mfma_f32_16x16x32_bf16 v[80:83], v[184:187], v[200:203], v[80:83]
    v_mfma_f32_16x16x32_bf16 v[84:87], v[184:187], v[204:207], v[84:87]
    v_mfma_f32_16x16x32_bf16 v[88:91], v[184:187], v[208:211], v[88:91]
    v_mfma_f32_16x16x32_bf16 v[92:95], v[184:187], v[212:215], v[92:95]
    v_mfma_f32_16x16x32_bf16 v[96:99], v[188:191], v[200:203], v[96:99]
    v_mfma_f32_16x16x32_bf16 v[100:103], v[188:191], v[204:207], v[100:103]
    v_mfma_f32_16x16x32_bf16 v[104:107], v[188:191], v[208:211], v[104:107]
    v_mfma_f32_16x16x32_bf16 v[108:111], v[188:191], v[212:215], v[108:111]
    v_mfma_f32_16x16x32_bf16 v[112:115], v[192:195], v[200:203], v[112:115]
    v_mfma_f32_16x16x32_bf16 v[116:119], v[192:195], v[204:207], v[116:119]
    v_mfma_f32_16x16x32_bf16 v[120:123], v[192:195], v[208:211], v[120:123]
    v_mfma_f32_16x16x32_bf16 v[124:127], v[192:195], v[212:215], v[124:127]
    v_mfma_f32_16x16x32_bf16 v[128:131], v[196:199], v[200:203], v[128:131]
    v_mfma_f32_16x16x32_bf16 v[132:135], v[196:199], v[204:207], v[132:135]
    v_mfma_f32_16x16x32_bf16 v[136:139], v[196:199], v[208:211], v[136:139]
    v_mfma_f32_16x16x32_bf16 v[140:143], v[196:199], v[212:215], v[140:143]
    buffer_load_dwordx4 v[180:183], v3, s[24:27], s40 offen sc1
    buffer_load_dwordx4 v[184:187], v3, s[24:27], s41 offen sc1
    buffer_load_dwordx4 v[188:191], v3, s[24:27], s42 offen sc1
    buffer_load_dwordx4 v[192:195], v3, s[24:27], s43 offen sc1
    buffer_load_dwordx4 v[196:199], v3, s[24:27], s46 offen sc1
    buffer_load_dwordx4 v[200:203], v3, s[24:27], s36 offen sc1
    buffer_load_dwordx4 v[204:207], v3, s[24:27], s37 offen sc1
    buffer_load_dwordx4 v[208:211], v3, s[24:27], s38 offen sc1
    buffer_load_dwordx4 v[212:215], v3, s[24:27], s39 offen sc1
    s_waitcnt vmcnt(21)
    v_mfma_f32_16x16x32_bf16 v[64:67], v[216:219], v[236:239], v[64:67]
    s_waitcnt vmcnt(20)
    v_mfma_f32_16x16x32_bf16 v[68:71], v[216:219], v[240:243], v[68:71]
    s_waitcnt vmcnt(19)
    v_mfma_f32_16x16x32_bf16 v[72:75], v[216:219], v[244:247], v[72:75]
    s_waitcnt vmcnt(18)
    v_mfma_f32_16x16x32_bf16 v[76:79], v[216:219], v[248:251], v[76:79]
    v_mfma_f32_16x16x32_bf16 v[80:83], v[220:223], v[236:239], v[80:83]
    v_mfma_f32_16x16x32_bf16 v[84:87], v[220:223], v[240:243], v[84:87]
    v_mfma_f32_16x16x32_bf16 v[88:91], v[220:223], v[244:247], v[88:91]
    v_mfma_f32_16x16x32_bf16 v[92:95], v[220:223], v[248:251], v[92:95]
    v_mfma_f32_16x16x32_bf16 v[96:99], v[224:227], v[236:239], v[96:99]
    v_mfma_f32_16x16x32_bf16 v[100:103], v[224:227], v[240:243], v[100:103]
    v_mfma_f32_16x16x32_bf16 v[104:107], v[224:227], v[244:247], v[104:107]
    v_mfma_f32_16x16x32_bf16 v[108:111], v[224:227], v[248:251], v[108:111]
    v_mfma_f32_16x16x32_bf16 v[112:115], v[228:231], v[236:239], v[112:115]
    v_mfma_f32_16x16x32_bf16 v[116:119], v[228:231], v[240:243], v[116:119]
    v_mfma_f32_16x16x32_bf16 v[120:123], v[228:231], v[244:247], v[120:123]
    v_mfma_f32_16x16x32_bf16 v[124:127], v[228:231], v[248:251], v[124:127]
    v_mfma_f32_16x16x32_bf16 v[128:131], v[232:235], v[236:239], v[128:131]
    v_mfma_f32_16x16x32_bf16 v[132:135], v[232:235], v[240:243], v[132:135]
    v_mfma_f32_16x16x32_bf16 v[136:139], v[232:235], v[244:247], v[136:139]
    v_mfma_f32_16x16x32_bf16 v[140:143], v[232:235], v[248:251], v[140:143]
    buffer_load_dwordx4 v[216:219], v3, s[24:27], s40 offen offset:1024 sc1
    buffer_load_dwordx4 v[220:223], v3, s[24:27], s41 offen offset:1024 sc1
    buffer_load_dwordx4 v[224:227], v3, s[24:27], s42 offen offset:1024 sc1
    buffer_load_dwordx4 v[228:231], v3, s[24:27], s43 offen offset:1024 sc1
    buffer_load_dwordx4 v[232:235], v3, s[24:27], s46 offen offset:1024 sc1
    buffer_load_dwordx4 v[236:239], v3, s[24:27], s36 offen offset:1024 sc1
    buffer_load_dwordx4 v[240:243], v3, s[24:27], s37 offen offset:1024 sc1
    buffer_load_dwordx4 v[244:247], v3, s[24:27], s38 offen offset:1024 sc1
    buffer_load_dwordx4 v[248:251], v3, s[24:27], s39 offen offset:1024 sc1
    s_waitcnt vmcnt(21)
    v_mfma_f32_16x16x32_bf16 v[64:67], v[144:147], v[164:167], v[64:67]
    s_waitcnt vmcnt(20)
    v_mfma_f32_16x16x32_bf16 v[68:71], v[144:147], v[168:171], v[68:71]
    s_waitcnt vmcnt(19)
    v_mfma_f32_16x16x32_bf16 v[72:75], v[144:147], v[172:175], v[72:75]
    s_waitcnt vmcnt(18)
    v_mfma_f32_16x16x32_bf16 v[76:79], v[144:147], v[176:179], v[76:79]
    v_mfma_f32_16x16x32_bf16 v[80:83], v[148:151], v[164:167], v[80:83]
    v_mfma_f32_16x16x32_bf16 v[84:87], v[148:151], v[168:171], v[84:87]
    v_mfma_f32_16x16x32_bf16 v[88:91], v[148:151], v[172:175], v[88:91]
    v_mfma_f32_16x16x32_bf16 v[92:95], v[148:151], v[176:179], v[92:95]
    v_mfma_f32_16x16x32_bf16 v[96:99], v[152:155], v[164:167], v[96:99]
    v_mfma_f32_16x16x32_bf16 v[100:103], v[152:155], v[168:171], v[100:103]
    v_mfma_f32_16x16x32_bf16 v[104:107], v[152:155], v[172:175], v[104:107]
    v_mfma_f32_16x16x32_bf16 v[108:111], v[152:155], v[176:179], v[108:111]
    v_mfma_f32_16x16x32_bf16 v[112:115], v[156:159], v[164:167], v[112:115]
    v_mfma_f32_16x16x32_bf16 v[116:119], v[156:159], v[168:171], v[116:119]
    v_mfma_f32_16x16x32_bf16 v[120:123], v[156:159], v[172:175], v[120:123]
    v_mfma_f32_16x16x32_bf16 v[124:127], v[156:159], v[176:179], v[124:127]
    v_mfma_f32_16x16x32_bf16 v[128:131], v[160:163], v[164:167], v[128:131]
    v_mfma_f32_16x16x32_bf16 v[132:135], v[160:163], v[168:171], v[132:135]
    v_mfma_f32_16x16x32_bf16 v[136:139], v[160:163], v[172:175], v[136:139]
    v_mfma_f32_16x16x32_bf16 v[140:143], v[160:163], v[176:179], v[140:143]
    buffer_load_dwordx4 v[144:147], v3, s[24:27], s40 offen offset:2048 sc1
    buffer_load_dwordx4 v[148:151], v3, s[24:27], s41 offen offset:2048 sc1
    buffer_load_dwordx4 v[152:155], v3, s[24:27], s42 offen offset:2048 sc1
    buffer_load_dwordx4 v[156:159], v3, s[24:27], s43 offen offset:2048 sc1
    buffer_load_dwordx4 v[160:163], v3, s[24:27], s46 offen offset:2048 sc1
    buffer_load_dwordx4 v[164:167], v3, s[24:27], s36 offen offset:2048 sc1
    buffer_load_dwordx4 v[168:171], v3, s[24:27], s37 offen offset:2048 sc1
    buffer_load_dwordx4 v[172:175], v3, s[24:27], s38 offen offset:2048 sc1
    buffer_load_dwordx4 v[176:179], v3, s[24:27], s39 offen offset:2048 sc1
    s_waitcnt vmcnt(21)
    v_mfma_f32_16x16x32_bf16 v[64:67], v[180:183], v[200:203], v[64:67]
    s_waitcnt vmcnt(20)
    v_mfma_f32_16x16x32_bf16 v[68:71], v[180:183], v[204:207], v[68:71]
    s_waitcnt vmcnt(19)
    v_mfma_f32_16x16x32_bf16 v[72:75], v[180:183], v[208:211], v[72:75]
    s_waitcnt vmcnt(18)
    v_mfma_f32_16x16x32_bf16 v[76:79], v[180:183], v[212:215], v[76:79]
    v_mfma_f32_16x16x32_bf16 v[80:83], v[184:187], v[200:203], v[80:83]
    v_mfma_f32_16x16x32_bf16 v[84:87], v[184:187], v[204:207], v[84:87]
    v_mfma_f32_16x16x32_bf16 v[88:91], v[184:187], v[208:211], v[88:91]
    v_mfma_f32_16x16x32_bf16 v[92:95], v[184:187], v[212:215], v[92:95]
    v_mfma_f32_16x16x32_bf16 v[96:99], v[188:191], v[200:203], v[96:99]
    v_mfma_f32_16x16x32_bf16 v[100:103], v[188:191], v[204:207], v[100:103]
    v_mfma_f32_16x16x32_bf16 v[104:107], v[188:191], v[208:211], v[104:107]
    v_mfma_f32_16x16x32_bf16 v[108:111], v[188:191], v[212:215], v[108:111]
    v_mfma_f32_16x16x32_bf16 v[112:115], v[192:195], v[200:203], v[112:115]
    v_mfma_f32_16x16x32_bf16 v[116:119], v[192:195], v[204:207], v[116:119]
    v_mfma_f32_16x16x32_bf16 v[120:123], v[192:195], v[208:211], v[120:123]
    v_mfma_f32_16x16x32_bf16 v[124:127], v[192:195], v[212:215], v[124:127]
    v_mfma_f32_16x16x32_bf16 v[128:131], v[196:199], v[200:203], v[128:131]
    v_mfma_f32_16x16x32_bf16 v[132:135], v[196:199], v[204:207], v[132:135]
    v_mfma_f32_16x16x32_bf16 v[136:139], v[196:199], v[208:211], v[136:139]
    v_mfma_f32_16x16x32_bf16 v[140:143], v[196:199], v[212:215], v[140:143]
    buffer_load_dwordx4 v[180:183], v3, s[24:27], s40 offen offset:3072 sc1
    buffer_load_dwordx4 v[184:187], v3, s[24:27], s41 offen offset:3072 sc1
    buffer_load_dwordx4 v[188:191], v3, s[24:27], s42 offen offset:3072 sc1
    buffer_load_dwordx4 v[192:195], v3, s[24:27], s43 offen offset:3072 sc1
    buffer_load_dwordx4 v[196:199], v3, s[24:27], s46 offen offset:3072 sc1
    buffer_load_dwordx4 v[200:203], v3, s[24:27], s36 offen offset:3072 sc1
    buffer_load_dwordx4 v[204:207], v3, s[24:27], s37 offen offset:3072 sc1
    buffer_load_dwordx4 v[208:211], v3, s[24:27], s38 offen offset:3072 sc1
    buffer_load_dwordx4 v[212:215], v3, s[24:27], s39 offen offset:3072 sc1
    s_waitcnt vmcnt(21)
    v_mfma_f32_16x16x32_bf16 v[64:67], v[216:219], v[236:239], v[64:67]
    s_waitcnt vmcnt(20)
    v_mfma_f32_16x16x32_bf16 v[68:71], v[216:219], v[240:243], v[68:71]
    s_waitcnt vmcnt(19)
    v_mfma_f32_16x16x32_bf16 v[72:75], v[216:219], v[244:247], v[72:75]
    s_waitcnt vmcnt(18)
    v_mfma_f32_16x16x32_bf16 v[76:79], v[216:219], v[248:251], v[76:79]
    v_mfma_f32_16x16x32_bf16 v[80:83], v[220:223], v[236:239], v[80:83]
    v_mfma_f32_16x16x32_bf16 v[84:87], v[220:223], v[240:243], v[84:87]
    v_mfma_f32_16x16x32_bf16 v[88:91], v[220:223], v[244:247], v[88:91]
    v_mfma_f32_16x16x32_bf16 v[92:95], v[220:223], v[248:251], v[92:95]
    v_mfma_f32_16x16x32_bf16 v[96:99], v[224:227], v[236:239], v[96:99]
    v_mfma_f32_16x16x32_bf16 v[100:103], v[224:227], v[240:243], v[100:103]
    v_mfma_f32_16x16x32_bf16 v[104:107], v[224:227], v[244:247], v[104:107]
    v_mfma_f32_16x16x32_bf16 v[108:111], v[224:227], v[248:251], v[108:111]
    v_mfma_f32_16x16x32_bf16 v[112:115], v[228:231], v[236:239], v[112:115]
    v_mfma_f32_16x16x32_bf16 v[116:119], v[228:231], v[240:243], v[116:119]
    v_mfma_f32_16x16x32_bf16 v[120:123], v[228:231], v[244:247], v[120:123]
    v_mfma_f32_16x16x32_bf16 v[124:127], v[228:231], v[248:251], v[124:127]
    v_mfma_f32_16x16x32_bf16 v[128:131], v[232:235], v[236:239], v[128:131]
    v_mfma_f32_16x16x32_bf16 v[132:135], v[232:235], v[240:243], v[132:135]
    v_mfma_f32_16x16x32_bf16 v[136:139], v[232:235], v[244:247], v[136:139]
    v_mfma_f32_16x16x32_bf16 v[140:143], v[232:235], v[248:251], v[140:143]
    s_waitcnt vmcnt(12)
    v_mfma_f32_16x16x32_bf16 v[64:67], v[144:147], v[164:167], v[64:67]
    s_waitcnt vmcnt(11)
    v_mfma_f32_16x16x32_bf16 v[68:71], v[144:147], v[168:171], v[68:71]
    s_waitcnt vmcnt(10)
    v_mfma_f32_16x16x32_bf16 v[72:75], v[144:147], v[172:175], v[72:75]
    s_waitcnt vmcnt(9)
    v_mfma_f32_16x16x32_bf16 v[76:79], v[144:147], v[176:179], v[76:79]
    v_mfma_f32_16x16x32_bf16 v[80:83], v[148:151], v[164:167], v[80:83]
    v_mfma_f32_16x16x32_bf16 v[84:87], v[148:151], v[168:171], v[84:87]
    v_mfma_f32_16x16x32_bf16 v[88:91], v[148:151], v[172:175], v[88:91]
    v_mfma_f32_16x16x32_bf16 v[92:95], v[148:151], v[176:179], v[92:95]
    v_mfma_f32_16x16x32_bf16 v[96:99], v[152:155], v[164:167], v[96:99]
    v_mfma_f32_16x16x32_bf16 v[100:103], v[152:155], v[168:171], v[100:103]
    v_mfma_f32_16x16x32_bf16 v[104:107], v[152:155], v[172:175], v[104:107]
    v_mfma_f32_16x16x32_bf16 v[108:111], v[152:155], v[176:179], v[108:111]
    v_mfma_f32_16x16x32_bf16 v[112:115], v[156:159], v[164:167], v[112:115]
    v_mfma_f32_16x16x32_bf16 v[116:119], v[156:159], v[168:171], v[116:119]
    v_mfma_f32_16x16x32_bf16 v[120:123], v[156:159], v[172:175], v[120:123]
    v_mfma_f32_16x16x32_bf16 v[124:127], v[156:159], v[176:179], v[124:127]
    v_mfma_f32_16x16x32_bf16 v[128:131], v[160:163], v[164:167], v[128:131]
    v_mfma_f32_16x16x32_bf16 v[132:135], v[160:163], v[168:171], v[132:135]
    v_mfma_f32_16x16x32_bf16 v[136:139], v[160:163], v[172:175], v[136:139]
    v_mfma_f32_16x16x32_bf16 v[140:143], v[160:163], v[176:179], v[140:143]
    s_waitcnt vmcnt(3)
    v_mfma_f32_16x16x32_bf16 v[64:67], v[180:183], v[200:203], v[64:67]
    s_waitcnt vmcnt(2)
    v_mfma_f32_16x16x32_bf16 v[68:71], v[180:183], v[204:207], v[68:71]
    s_waitcnt vmcnt(1)
    v_mfma_f32_16x16x32_bf16 v[72:75], v[180:183], v[208:211], v[72:75]
    s_waitcnt vmcnt(0)
    v_mfma_f32_16x16x32_bf16 v[76:79], v[180:183], v[212:215], v[76:79]
    v_mfma_f32_16x16x32_bf16 v[80:83], v[184:187], v[200:203], v[80:83]
    v_mfma_f32_16x16x32_bf16 v[84:87], v[184:187], v[204:207], v[84:87]
    v_mfma_f32_16x16x32_bf16 v[88:91], v[184:187], v[208:211], v[88:91]
    v_mfma_f32_16x16x32_bf16 v[92:95], v[184:187], v[212:215], v[92:95]
    v_mfma_f32_16x16x32_bf16 v[96:99], v[188:191], v[200:203], v[96:99]
    v_mfma_f32_16x16x32_bf16 v[100:103], v[188:191], v[204:207], v[100:103]
    v_mfma_f32_16x16x32_bf16 v[104:107], v[188:191], v[208:211], v[104:107]
    v_mfma_f32_16x16x32_bf16 v[108:111], v[188:191], v[212:215], v[108:111]
    v_mfma_f32_16x16x32_bf16 v[112:115], v[192:195], v[200:203], v[112:115]
    v_mfma_f32_16x16x32_bf16 v[116:119], v[192:195], v[204:207], v[116:119]
    v_mfma_f32_16x16x32_bf16 v[120:123], v[192:195], v[208:211], v[120:123]
    v_mfma_f32_16x16x32_bf16 v[124:127], v[192:195], v[212:215], v[124:127]
    v_mfma_f32_16x16x32_bf16 v[128:131], v[196:199], v[200:203], v[128:131]
    v_mfma_f32_16x16x32_bf16 v[132:135], v[196:199], v[204:207], v[132:135]
    v_mfma_f32_16x16x32_bf16 v[136:139], v[196:199], v[208:211], v[136:139]
    v_mfma_f32_16x16x32_bf16 v[140:143], v[196:199], v[212:215], v[140:143]
    s_branch standalone__mha_block_cached__near_ridge_kernel_Tred
standalone__mha_block_cached__near_ridge_kernel_TVP:
    s_cmp_lg_u32 s3, 4
    s_cbranch_scc1 standalone__mha_block_cached__near_ridge_kernel_g2o
    s_lshr_b32 s51, s4, 1
    s_lshl_b32 s51, s51, 2
    s_add_u32 s51, s51, 64
    v_cmp_eq_u32 vcc, 0, v0
    v_mov_b32 v7, s51
    s_nop 1
    v_cndmask_b32 v7, v7, v6, vcc
    s_mov_b32 s63, 0
standalone__mha_block_cached__near_ridge_kernel_g2p:
    s_mov_b64 exec, 3
    buffer_load_dword v8, v7, s[16:19], 0 offen sc1
    s_mov_b64 exec, -1
    s_waitcnt vmcnt(0)
    v_readlane_b32 s33, v8, 0
    v_readlane_b32 s35, v8, 1
    s_nop 3
    s_cmp_ge_u32 s33, 256
    s_cselect_b32 s61, 1, 0
    s_cmp_ge_u32 s35, 16
    s_cselect_b32 s61, s61, 0
    s_cmp_lg_u32 s61, 0
    s_cbranch_scc1 standalone__mha_block_cached__near_ridge_kernel_g2s
    s_sleep 16
    s_add_u32 s63, s63, 1
    s_cmp_lt_u32 s63, 0x80000
    s_cbranch_scc1 standalone__mha_block_cached__near_ridge_kernel_g2p
standalone__mha_block_cached__near_ridge_kernel_g2s:
    v_mov_b32 v8, 1
    ds_write_b32 v6, v8 offset:8
    s_waitcnt lgkmcnt(0)
    s_branch standalone__mha_block_cached__near_ridge_kernel_g2d
standalone__mha_block_cached__near_ridge_kernel_g2o:
    s_mov_b32 s63, 0
standalone__mha_block_cached__near_ridge_kernel_g2oo:
    ds_read_b32 v8, v6 offset:8
    s_waitcnt lgkmcnt(0)
    v_readfirstlane_b32 s61, v8
    s_nop 3
    s_cmp_lg_u32 s61, 0
    s_cbranch_scc1 standalone__mha_block_cached__near_ridge_kernel_g2d
    s_sleep 2
    s_add_u32 s63, s63, 1
    s_cmp_lt_u32 s63, 0x800000
    s_cbranch_scc1 standalone__mha_block_cached__near_ridge_kernel_g2oo
standalone__mha_block_cached__near_ridge_kernel_g2d:
    s_sub_u32 s62, s3, 4
    s_mul_i32 s62, s62, 10
    s_lshl_b32 s33, s4, 9
    s_add_u32 s33, s33, s62
    s_lshl_b32 s33, s33, 10
    s_add_u32 s36, s33, 0
    s_add_u32 s37, s33, 131072
    s_add_u32 s38, s33, 262144
    s_add_u32 s39, s33, 393216
    s_mul_i32 s33, s5, 640
    s_add_u32 s33, s33, s62
    s_lshl_b32 s33, s33, 10
    s_add_u32 s40, s33, 25165824
    s_add_u32 s41, s33, 25296896
    s_add_u32 s42, s33, 25427968
    s_add_u32 s43, s33, 25559040
    s_add_u32 s46, s33, 25690112
    buffer_load_dwordx4 v[144:147], v2, s[24:27], s40 offen sc1
    buffer_load_dwordx4 v[148:151], v2, s[24:27], s41 offen sc1
    buffer_load_dwordx4 v[152:155], v2, s[24:27], s42 offen sc1
    buffer_load_dwordx4 v[156:159], v2, s[24:27], s43 offen sc1
    buffer_load_dwordx4 v[160:163], v2, s[24:27], s46 offen sc1
    buffer_load_dwordx4 v[164:167], v2, s[24:27], s36 offen sc1
    buffer_load_dwordx4 v[168:171], v2, s[24:27], s37 offen sc1
    buffer_load_dwordx4 v[172:175], v2, s[24:27], s38 offen sc1
    buffer_load_dwordx4 v[176:179], v2, s[24:27], s39 offen sc1
    buffer_load_dwordx4 v[180:183], v2, s[24:27], s40 offen offset:1024 sc1
    buffer_load_dwordx4 v[184:187], v2, s[24:27], s41 offen offset:1024 sc1
    buffer_load_dwordx4 v[188:191], v2, s[24:27], s42 offen offset:1024 sc1
    buffer_load_dwordx4 v[192:195], v2, s[24:27], s43 offen offset:1024 sc1
    buffer_load_dwordx4 v[196:199], v2, s[24:27], s46 offen offset:1024 sc1
    buffer_load_dwordx4 v[200:203], v2, s[24:27], s36 offen offset:1024 sc1
    buffer_load_dwordx4 v[204:207], v2, s[24:27], s37 offen offset:1024 sc1
    buffer_load_dwordx4 v[208:211], v2, s[24:27], s38 offen offset:1024 sc1
    buffer_load_dwordx4 v[212:215], v2, s[24:27], s39 offen offset:1024 sc1
    buffer_load_dwordx4 v[216:219], v2, s[24:27], s40 offen offset:2048 sc1
    buffer_load_dwordx4 v[220:223], v2, s[24:27], s41 offen offset:2048 sc1
    buffer_load_dwordx4 v[224:227], v2, s[24:27], s42 offen offset:2048 sc1
    buffer_load_dwordx4 v[228:231], v2, s[24:27], s43 offen offset:2048 sc1
    buffer_load_dwordx4 v[232:235], v2, s[24:27], s46 offen offset:2048 sc1
    buffer_load_dwordx4 v[236:239], v2, s[24:27], s36 offen offset:2048 sc1
    buffer_load_dwordx4 v[240:243], v2, s[24:27], s37 offen offset:2048 sc1
    buffer_load_dwordx4 v[244:247], v2, s[24:27], s38 offen offset:2048 sc1
    buffer_load_dwordx4 v[248:251], v2, s[24:27], s39 offen offset:2048 sc1
    s_waitcnt vmcnt(21)
    v_mfma_f32_16x16x32_bf16 v[64:67], v[144:147], v[164:167], v[64:67]
    s_waitcnt vmcnt(20)
    v_mfma_f32_16x16x32_bf16 v[68:71], v[144:147], v[168:171], v[68:71]
    s_waitcnt vmcnt(19)
    v_mfma_f32_16x16x32_bf16 v[72:75], v[144:147], v[172:175], v[72:75]
    s_waitcnt vmcnt(18)
    v_mfma_f32_16x16x32_bf16 v[76:79], v[144:147], v[176:179], v[76:79]
    v_mfma_f32_16x16x32_bf16 v[80:83], v[148:151], v[164:167], v[80:83]
    v_mfma_f32_16x16x32_bf16 v[84:87], v[148:151], v[168:171], v[84:87]
    v_mfma_f32_16x16x32_bf16 v[88:91], v[148:151], v[172:175], v[88:91]
    v_mfma_f32_16x16x32_bf16 v[92:95], v[148:151], v[176:179], v[92:95]
    v_mfma_f32_16x16x32_bf16 v[96:99], v[152:155], v[164:167], v[96:99]
    v_mfma_f32_16x16x32_bf16 v[100:103], v[152:155], v[168:171], v[100:103]
    v_mfma_f32_16x16x32_bf16 v[104:107], v[152:155], v[172:175], v[104:107]
    v_mfma_f32_16x16x32_bf16 v[108:111], v[152:155], v[176:179], v[108:111]
    v_mfma_f32_16x16x32_bf16 v[112:115], v[156:159], v[164:167], v[112:115]
    v_mfma_f32_16x16x32_bf16 v[116:119], v[156:159], v[168:171], v[116:119]
    v_mfma_f32_16x16x32_bf16 v[120:123], v[156:159], v[172:175], v[120:123]
    v_mfma_f32_16x16x32_bf16 v[124:127], v[156:159], v[176:179], v[124:127]
    v_mfma_f32_16x16x32_bf16 v[128:131], v[160:163], v[164:167], v[128:131]
    v_mfma_f32_16x16x32_bf16 v[132:135], v[160:163], v[168:171], v[132:135]
    v_mfma_f32_16x16x32_bf16 v[136:139], v[160:163], v[172:175], v[136:139]
    v_mfma_f32_16x16x32_bf16 v[140:143], v[160:163], v[176:179], v[140:143]
    buffer_load_dwordx4 v[144:147], v2, s[24:27], s40 offen offset:3072 sc1
    buffer_load_dwordx4 v[148:151], v2, s[24:27], s41 offen offset:3072 sc1
    buffer_load_dwordx4 v[152:155], v2, s[24:27], s42 offen offset:3072 sc1
    buffer_load_dwordx4 v[156:159], v2, s[24:27], s43 offen offset:3072 sc1
    buffer_load_dwordx4 v[160:163], v2, s[24:27], s46 offen offset:3072 sc1
    buffer_load_dwordx4 v[164:167], v2, s[24:27], s36 offen offset:3072 sc1
    buffer_load_dwordx4 v[168:171], v2, s[24:27], s37 offen offset:3072 sc1
    buffer_load_dwordx4 v[172:175], v2, s[24:27], s38 offen offset:3072 sc1
    buffer_load_dwordx4 v[176:179], v2, s[24:27], s39 offen offset:3072 sc1
    s_waitcnt vmcnt(21)
    v_mfma_f32_16x16x32_bf16 v[64:67], v[180:183], v[200:203], v[64:67]
    s_waitcnt vmcnt(20)
    v_mfma_f32_16x16x32_bf16 v[68:71], v[180:183], v[204:207], v[68:71]
    s_waitcnt vmcnt(19)
    v_mfma_f32_16x16x32_bf16 v[72:75], v[180:183], v[208:211], v[72:75]
    s_waitcnt vmcnt(18)
    v_mfma_f32_16x16x32_bf16 v[76:79], v[180:183], v[212:215], v[76:79]
    v_mfma_f32_16x16x32_bf16 v[80:83], v[184:187], v[200:203], v[80:83]
    v_mfma_f32_16x16x32_bf16 v[84:87], v[184:187], v[204:207], v[84:87]
    v_mfma_f32_16x16x32_bf16 v[88:91], v[184:187], v[208:211], v[88:91]
    v_mfma_f32_16x16x32_bf16 v[92:95], v[184:187], v[212:215], v[92:95]
    v_mfma_f32_16x16x32_bf16 v[96:99], v[188:191], v[200:203], v[96:99]
    v_mfma_f32_16x16x32_bf16 v[100:103], v[188:191], v[204:207], v[100:103]
    v_mfma_f32_16x16x32_bf16 v[104:107], v[188:191], v[208:211], v[104:107]
    v_mfma_f32_16x16x32_bf16 v[108:111], v[188:191], v[212:215], v[108:111]
    v_mfma_f32_16x16x32_bf16 v[112:115], v[192:195], v[200:203], v[112:115]
    v_mfma_f32_16x16x32_bf16 v[116:119], v[192:195], v[204:207], v[116:119]
    v_mfma_f32_16x16x32_bf16 v[120:123], v[192:195], v[208:211], v[120:123]
    v_mfma_f32_16x16x32_bf16 v[124:127], v[192:195], v[212:215], v[124:127]
    v_mfma_f32_16x16x32_bf16 v[128:131], v[196:199], v[200:203], v[128:131]
    v_mfma_f32_16x16x32_bf16 v[132:135], v[196:199], v[204:207], v[132:135]
    v_mfma_f32_16x16x32_bf16 v[136:139], v[196:199], v[208:211], v[136:139]
    v_mfma_f32_16x16x32_bf16 v[140:143], v[196:199], v[212:215], v[140:143]
    buffer_load_dwordx4 v[180:183], v3, s[24:27], s40 offen sc1
    buffer_load_dwordx4 v[184:187], v3, s[24:27], s41 offen sc1
    buffer_load_dwordx4 v[188:191], v3, s[24:27], s42 offen sc1
    buffer_load_dwordx4 v[192:195], v3, s[24:27], s43 offen sc1
    buffer_load_dwordx4 v[196:199], v3, s[24:27], s46 offen sc1
    buffer_load_dwordx4 v[200:203], v3, s[24:27], s36 offen sc1
    buffer_load_dwordx4 v[204:207], v3, s[24:27], s37 offen sc1
    buffer_load_dwordx4 v[208:211], v3, s[24:27], s38 offen sc1
    buffer_load_dwordx4 v[212:215], v3, s[24:27], s39 offen sc1
    s_waitcnt vmcnt(21)
    v_mfma_f32_16x16x32_bf16 v[64:67], v[216:219], v[236:239], v[64:67]
    s_waitcnt vmcnt(20)
    v_mfma_f32_16x16x32_bf16 v[68:71], v[216:219], v[240:243], v[68:71]
    s_waitcnt vmcnt(19)
    v_mfma_f32_16x16x32_bf16 v[72:75], v[216:219], v[244:247], v[72:75]
    s_waitcnt vmcnt(18)
    v_mfma_f32_16x16x32_bf16 v[76:79], v[216:219], v[248:251], v[76:79]
    v_mfma_f32_16x16x32_bf16 v[80:83], v[220:223], v[236:239], v[80:83]
    v_mfma_f32_16x16x32_bf16 v[84:87], v[220:223], v[240:243], v[84:87]
    v_mfma_f32_16x16x32_bf16 v[88:91], v[220:223], v[244:247], v[88:91]
    v_mfma_f32_16x16x32_bf16 v[92:95], v[220:223], v[248:251], v[92:95]
    v_mfma_f32_16x16x32_bf16 v[96:99], v[224:227], v[236:239], v[96:99]
    v_mfma_f32_16x16x32_bf16 v[100:103], v[224:227], v[240:243], v[100:103]
    v_mfma_f32_16x16x32_bf16 v[104:107], v[224:227], v[244:247], v[104:107]
    v_mfma_f32_16x16x32_bf16 v[108:111], v[224:227], v[248:251], v[108:111]
    v_mfma_f32_16x16x32_bf16 v[112:115], v[228:231], v[236:239], v[112:115]
    v_mfma_f32_16x16x32_bf16 v[116:119], v[228:231], v[240:243], v[116:119]
    v_mfma_f32_16x16x32_bf16 v[120:123], v[228:231], v[244:247], v[120:123]
    v_mfma_f32_16x16x32_bf16 v[124:127], v[228:231], v[248:251], v[124:127]
    v_mfma_f32_16x16x32_bf16 v[128:131], v[232:235], v[236:239], v[128:131]
    v_mfma_f32_16x16x32_bf16 v[132:135], v[232:235], v[240:243], v[132:135]
    v_mfma_f32_16x16x32_bf16 v[136:139], v[232:235], v[244:247], v[136:139]
    v_mfma_f32_16x16x32_bf16 v[140:143], v[232:235], v[248:251], v[140:143]
    buffer_load_dwordx4 v[216:219], v3, s[24:27], s40 offen offset:1024 sc1
    buffer_load_dwordx4 v[220:223], v3, s[24:27], s41 offen offset:1024 sc1
    buffer_load_dwordx4 v[224:227], v3, s[24:27], s42 offen offset:1024 sc1
    buffer_load_dwordx4 v[228:231], v3, s[24:27], s43 offen offset:1024 sc1
    buffer_load_dwordx4 v[232:235], v3, s[24:27], s46 offen offset:1024 sc1
    buffer_load_dwordx4 v[236:239], v3, s[24:27], s36 offen offset:1024 sc1
    buffer_load_dwordx4 v[240:243], v3, s[24:27], s37 offen offset:1024 sc1
    buffer_load_dwordx4 v[244:247], v3, s[24:27], s38 offen offset:1024 sc1
    buffer_load_dwordx4 v[248:251], v3, s[24:27], s39 offen offset:1024 sc1
    s_waitcnt vmcnt(21)
    v_mfma_f32_16x16x32_bf16 v[64:67], v[144:147], v[164:167], v[64:67]
    s_waitcnt vmcnt(20)
    v_mfma_f32_16x16x32_bf16 v[68:71], v[144:147], v[168:171], v[68:71]
    s_waitcnt vmcnt(19)
    v_mfma_f32_16x16x32_bf16 v[72:75], v[144:147], v[172:175], v[72:75]
    s_waitcnt vmcnt(18)
    v_mfma_f32_16x16x32_bf16 v[76:79], v[144:147], v[176:179], v[76:79]
    v_mfma_f32_16x16x32_bf16 v[80:83], v[148:151], v[164:167], v[80:83]
    v_mfma_f32_16x16x32_bf16 v[84:87], v[148:151], v[168:171], v[84:87]
    v_mfma_f32_16x16x32_bf16 v[88:91], v[148:151], v[172:175], v[88:91]
    v_mfma_f32_16x16x32_bf16 v[92:95], v[148:151], v[176:179], v[92:95]
    v_mfma_f32_16x16x32_bf16 v[96:99], v[152:155], v[164:167], v[96:99]
    v_mfma_f32_16x16x32_bf16 v[100:103], v[152:155], v[168:171], v[100:103]
    v_mfma_f32_16x16x32_bf16 v[104:107], v[152:155], v[172:175], v[104:107]
    v_mfma_f32_16x16x32_bf16 v[108:111], v[152:155], v[176:179], v[108:111]
    v_mfma_f32_16x16x32_bf16 v[112:115], v[156:159], v[164:167], v[112:115]
    v_mfma_f32_16x16x32_bf16 v[116:119], v[156:159], v[168:171], v[116:119]
    v_mfma_f32_16x16x32_bf16 v[120:123], v[156:159], v[172:175], v[120:123]
    v_mfma_f32_16x16x32_bf16 v[124:127], v[156:159], v[176:179], v[124:127]
    v_mfma_f32_16x16x32_bf16 v[128:131], v[160:163], v[164:167], v[128:131]
    v_mfma_f32_16x16x32_bf16 v[132:135], v[160:163], v[168:171], v[132:135]
    v_mfma_f32_16x16x32_bf16 v[136:139], v[160:163], v[172:175], v[136:139]
    v_mfma_f32_16x16x32_bf16 v[140:143], v[160:163], v[176:179], v[140:143]
    buffer_load_dwordx4 v[144:147], v3, s[24:27], s40 offen offset:2048 sc1
    buffer_load_dwordx4 v[148:151], v3, s[24:27], s41 offen offset:2048 sc1
    buffer_load_dwordx4 v[152:155], v3, s[24:27], s42 offen offset:2048 sc1
    buffer_load_dwordx4 v[156:159], v3, s[24:27], s43 offen offset:2048 sc1
    buffer_load_dwordx4 v[160:163], v3, s[24:27], s46 offen offset:2048 sc1
    buffer_load_dwordx4 v[164:167], v3, s[24:27], s36 offen offset:2048 sc1
    buffer_load_dwordx4 v[168:171], v3, s[24:27], s37 offen offset:2048 sc1
    buffer_load_dwordx4 v[172:175], v3, s[24:27], s38 offen offset:2048 sc1
    buffer_load_dwordx4 v[176:179], v3, s[24:27], s39 offen offset:2048 sc1
    s_waitcnt vmcnt(21)
    v_mfma_f32_16x16x32_bf16 v[64:67], v[180:183], v[200:203], v[64:67]
    s_waitcnt vmcnt(20)
    v_mfma_f32_16x16x32_bf16 v[68:71], v[180:183], v[204:207], v[68:71]
    s_waitcnt vmcnt(19)
    v_mfma_f32_16x16x32_bf16 v[72:75], v[180:183], v[208:211], v[72:75]
    s_waitcnt vmcnt(18)
    v_mfma_f32_16x16x32_bf16 v[76:79], v[180:183], v[212:215], v[76:79]
    v_mfma_f32_16x16x32_bf16 v[80:83], v[184:187], v[200:203], v[80:83]
    v_mfma_f32_16x16x32_bf16 v[84:87], v[184:187], v[204:207], v[84:87]
    v_mfma_f32_16x16x32_bf16 v[88:91], v[184:187], v[208:211], v[88:91]
    v_mfma_f32_16x16x32_bf16 v[92:95], v[184:187], v[212:215], v[92:95]
    v_mfma_f32_16x16x32_bf16 v[96:99], v[188:191], v[200:203], v[96:99]
    v_mfma_f32_16x16x32_bf16 v[100:103], v[188:191], v[204:207], v[100:103]
    v_mfma_f32_16x16x32_bf16 v[104:107], v[188:191], v[208:211], v[104:107]
    v_mfma_f32_16x16x32_bf16 v[108:111], v[188:191], v[212:215], v[108:111]
    v_mfma_f32_16x16x32_bf16 v[112:115], v[192:195], v[200:203], v[112:115]
    v_mfma_f32_16x16x32_bf16 v[116:119], v[192:195], v[204:207], v[116:119]
    v_mfma_f32_16x16x32_bf16 v[120:123], v[192:195], v[208:211], v[120:123]
    v_mfma_f32_16x16x32_bf16 v[124:127], v[192:195], v[212:215], v[124:127]
    v_mfma_f32_16x16x32_bf16 v[128:131], v[196:199], v[200:203], v[128:131]
    v_mfma_f32_16x16x32_bf16 v[132:135], v[196:199], v[204:207], v[132:135]
    v_mfma_f32_16x16x32_bf16 v[136:139], v[196:199], v[208:211], v[136:139]
    v_mfma_f32_16x16x32_bf16 v[140:143], v[196:199], v[212:215], v[140:143]
    buffer_load_dwordx4 v[180:183], v3, s[24:27], s40 offen offset:3072 sc1
    buffer_load_dwordx4 v[184:187], v3, s[24:27], s41 offen offset:3072 sc1
    buffer_load_dwordx4 v[188:191], v3, s[24:27], s42 offen offset:3072 sc1
    buffer_load_dwordx4 v[192:195], v3, s[24:27], s43 offen offset:3072 sc1
    buffer_load_dwordx4 v[196:199], v3, s[24:27], s46 offen offset:3072 sc1
    buffer_load_dwordx4 v[200:203], v3, s[24:27], s36 offen offset:3072 sc1
    buffer_load_dwordx4 v[204:207], v3, s[24:27], s37 offen offset:3072 sc1
    buffer_load_dwordx4 v[208:211], v3, s[24:27], s38 offen offset:3072 sc1
    buffer_load_dwordx4 v[212:215], v3, s[24:27], s39 offen offset:3072 sc1
    s_waitcnt vmcnt(21)
    v_mfma_f32_16x16x32_bf16 v[64:67], v[216:219], v[236:239], v[64:67]
    s_waitcnt vmcnt(20)
    v_mfma_f32_16x16x32_bf16 v[68:71], v[216:219], v[240:243], v[68:71]
    s_waitcnt vmcnt(19)
    v_mfma_f32_16x16x32_bf16 v[72:75], v[216:219], v[244:247], v[72:75]
    s_waitcnt vmcnt(18)
    v_mfma_f32_16x16x32_bf16 v[76:79], v[216:219], v[248:251], v[76:79]
    v_mfma_f32_16x16x32_bf16 v[80:83], v[220:223], v[236:239], v[80:83]
    v_mfma_f32_16x16x32_bf16 v[84:87], v[220:223], v[240:243], v[84:87]
    v_mfma_f32_16x16x32_bf16 v[88:91], v[220:223], v[244:247], v[88:91]
    v_mfma_f32_16x16x32_bf16 v[92:95], v[220:223], v[248:251], v[92:95]
    v_mfma_f32_16x16x32_bf16 v[96:99], v[224:227], v[236:239], v[96:99]
    v_mfma_f32_16x16x32_bf16 v[100:103], v[224:227], v[240:243], v[100:103]
    v_mfma_f32_16x16x32_bf16 v[104:107], v[224:227], v[244:247], v[104:107]
    v_mfma_f32_16x16x32_bf16 v[108:111], v[224:227], v[248:251], v[108:111]
    v_mfma_f32_16x16x32_bf16 v[112:115], v[228:231], v[236:239], v[112:115]
    v_mfma_f32_16x16x32_bf16 v[116:119], v[228:231], v[240:243], v[116:119]
    v_mfma_f32_16x16x32_bf16 v[120:123], v[228:231], v[244:247], v[120:123]
    v_mfma_f32_16x16x32_bf16 v[124:127], v[228:231], v[248:251], v[124:127]
    v_mfma_f32_16x16x32_bf16 v[128:131], v[232:235], v[236:239], v[128:131]
    v_mfma_f32_16x16x32_bf16 v[132:135], v[232:235], v[240:243], v[132:135]
    v_mfma_f32_16x16x32_bf16 v[136:139], v[232:235], v[244:247], v[136:139]
    v_mfma_f32_16x16x32_bf16 v[140:143], v[232:235], v[248:251], v[140:143]
    buffer_load_dwordx4 v[216:219], v4, s[24:27], s40 offen sc1
    buffer_load_dwordx4 v[220:223], v4, s[24:27], s41 offen sc1
    buffer_load_dwordx4 v[224:227], v4, s[24:27], s42 offen sc1
    buffer_load_dwordx4 v[228:231], v4, s[24:27], s43 offen sc1
    buffer_load_dwordx4 v[232:235], v4, s[24:27], s46 offen sc1
    buffer_load_dwordx4 v[236:239], v4, s[24:27], s36 offen sc1
    buffer_load_dwordx4 v[240:243], v4, s[24:27], s37 offen sc1
    buffer_load_dwordx4 v[244:247], v4, s[24:27], s38 offen sc1
    buffer_load_dwordx4 v[248:251], v4, s[24:27], s39 offen sc1
    s_waitcnt vmcnt(21)
    v_mfma_f32_16x16x32_bf16 v[64:67], v[144:147], v[164:167], v[64:67]
    s_waitcnt vmcnt(20)
    v_mfma_f32_16x16x32_bf16 v[68:71], v[144:147], v[168:171], v[68:71]
    s_waitcnt vmcnt(19)
    v_mfma_f32_16x16x32_bf16 v[72:75], v[144:147], v[172:175], v[72:75]
    s_waitcnt vmcnt(18)
    v_mfma_f32_16x16x32_bf16 v[76:79], v[144:147], v[176:179], v[76:79]
    v_mfma_f32_16x16x32_bf16 v[80:83], v[148:151], v[164:167], v[80:83]
    v_mfma_f32_16x16x32_bf16 v[84:87], v[148:151], v[168:171], v[84:87]
    v_mfma_f32_16x16x32_bf16 v[88:91], v[148:151], v[172:175], v[88:91]
    v_mfma_f32_16x16x32_bf16 v[92:95], v[148:151], v[176:179], v[92:95]
    v_mfma_f32_16x16x32_bf16 v[96:99], v[152:155], v[164:167], v[96:99]
    v_mfma_f32_16x16x32_bf16 v[100:103], v[152:155], v[168:171], v[100:103]
    v_mfma_f32_16x16x32_bf16 v[104:107], v[152:155], v[172:175], v[104:107]
    v_mfma_f32_16x16x32_bf16 v[108:111], v[152:155], v[176:179], v[108:111]
    v_mfma_f32_16x16x32_bf16 v[112:115], v[156:159], v[164:167], v[112:115]
    v_mfma_f32_16x16x32_bf16 v[116:119], v[156:159], v[168:171], v[116:119]
    v_mfma_f32_16x16x32_bf16 v[120:123], v[156:159], v[172:175], v[120:123]
    v_mfma_f32_16x16x32_bf16 v[124:127], v[156:159], v[176:179], v[124:127]
    v_mfma_f32_16x16x32_bf16 v[128:131], v[160:163], v[164:167], v[128:131]
    v_mfma_f32_16x16x32_bf16 v[132:135], v[160:163], v[168:171], v[132:135]
    v_mfma_f32_16x16x32_bf16 v[136:139], v[160:163], v[172:175], v[136:139]
    v_mfma_f32_16x16x32_bf16 v[140:143], v[160:163], v[176:179], v[140:143]
    buffer_load_dwordx4 v[144:147], v4, s[24:27], s40 offen offset:1024 sc1
    buffer_load_dwordx4 v[148:151], v4, s[24:27], s41 offen offset:1024 sc1
    buffer_load_dwordx4 v[152:155], v4, s[24:27], s42 offen offset:1024 sc1
    buffer_load_dwordx4 v[156:159], v4, s[24:27], s43 offen offset:1024 sc1
    buffer_load_dwordx4 v[160:163], v4, s[24:27], s46 offen offset:1024 sc1
    buffer_load_dwordx4 v[164:167], v4, s[24:27], s36 offen offset:1024 sc1
    buffer_load_dwordx4 v[168:171], v4, s[24:27], s37 offen offset:1024 sc1
    buffer_load_dwordx4 v[172:175], v4, s[24:27], s38 offen offset:1024 sc1
    buffer_load_dwordx4 v[176:179], v4, s[24:27], s39 offen offset:1024 sc1
    s_waitcnt vmcnt(21)
    v_mfma_f32_16x16x32_bf16 v[64:67], v[180:183], v[200:203], v[64:67]
    s_waitcnt vmcnt(20)
    v_mfma_f32_16x16x32_bf16 v[68:71], v[180:183], v[204:207], v[68:71]
    s_waitcnt vmcnt(19)
    v_mfma_f32_16x16x32_bf16 v[72:75], v[180:183], v[208:211], v[72:75]
    s_waitcnt vmcnt(18)
    v_mfma_f32_16x16x32_bf16 v[76:79], v[180:183], v[212:215], v[76:79]
    v_mfma_f32_16x16x32_bf16 v[80:83], v[184:187], v[200:203], v[80:83]
    v_mfma_f32_16x16x32_bf16 v[84:87], v[184:187], v[204:207], v[84:87]
    v_mfma_f32_16x16x32_bf16 v[88:91], v[184:187], v[208:211], v[88:91]
    v_mfma_f32_16x16x32_bf16 v[92:95], v[184:187], v[212:215], v[92:95]
    v_mfma_f32_16x16x32_bf16 v[96:99], v[188:191], v[200:203], v[96:99]
    v_mfma_f32_16x16x32_bf16 v[100:103], v[188:191], v[204:207], v[100:103]
    v_mfma_f32_16x16x32_bf16 v[104:107], v[188:191], v[208:211], v[104:107]
    v_mfma_f32_16x16x32_bf16 v[108:111], v[188:191], v[212:215], v[108:111]
    v_mfma_f32_16x16x32_bf16 v[112:115], v[192:195], v[200:203], v[112:115]
    v_mfma_f32_16x16x32_bf16 v[116:119], v[192:195], v[204:207], v[116:119]
    v_mfma_f32_16x16x32_bf16 v[120:123], v[192:195], v[208:211], v[120:123]
    v_mfma_f32_16x16x32_bf16 v[124:127], v[192:195], v[212:215], v[124:127]
    v_mfma_f32_16x16x32_bf16 v[128:131], v[196:199], v[200:203], v[128:131]
    v_mfma_f32_16x16x32_bf16 v[132:135], v[196:199], v[204:207], v[132:135]
    v_mfma_f32_16x16x32_bf16 v[136:139], v[196:199], v[208:211], v[136:139]
    v_mfma_f32_16x16x32_bf16 v[140:143], v[196:199], v[212:215], v[140:143]
    s_cmp_lg_u32 s3, 4
    s_cbranch_scc1 standalone__mha_block_cached__near_ridge_kernel_g3o
    s_lshr_b32 s51, s4, 1
    s_lshl_b32 s51, s51, 2
    s_add_u32 s51, s51, 128
    v_cmp_eq_u32 vcc, 0, v0
    v_mov_b32 v7, s51
    s_nop 1
    v_cndmask_b32 v7, v7, v6, vcc
    s_mov_b32 s63, 0
standalone__mha_block_cached__near_ridge_kernel_g3p:
    s_mov_b64 exec, 3
    buffer_load_dword v8, v7, s[16:19], 0 offen sc1
    s_mov_b64 exec, -1
    s_waitcnt vmcnt(0)
    v_readlane_b32 s33, v8, 0
    v_readlane_b32 s35, v8, 1
    s_nop 3
    s_cmp_ge_u32 s33, 256
    s_cselect_b32 s61, 1, 0
    s_cmp_ge_u32 s35, 16
    s_cselect_b32 s61, s61, 0
    s_cmp_lg_u32 s61, 0
    s_cbranch_scc1 standalone__mha_block_cached__near_ridge_kernel_g3s
    s_sleep 16
    s_add_u32 s63, s63, 1
    s_cmp_lt_u32 s63, 0x80000
    s_cbranch_scc1 standalone__mha_block_cached__near_ridge_kernel_g3p
standalone__mha_block_cached__near_ridge_kernel_g3s:
    v_mov_b32 v8, 1
    ds_write_b32 v6, v8 offset:4
    s_waitcnt lgkmcnt(0)
    s_branch standalone__mha_block_cached__near_ridge_kernel_g3d
standalone__mha_block_cached__near_ridge_kernel_g3o:
    s_mov_b32 s63, 0
standalone__mha_block_cached__near_ridge_kernel_g3oo:
    ds_read_b32 v8, v6 offset:4
    s_waitcnt lgkmcnt(0)
    v_readfirstlane_b32 s61, v8
    s_nop 3
    s_cmp_lg_u32 s61, 0
    s_cbranch_scc1 standalone__mha_block_cached__near_ridge_kernel_g3d
    s_sleep 2
    s_add_u32 s63, s63, 1
    s_cmp_lt_u32 s63, 0x800000
    s_cbranch_scc1 standalone__mha_block_cached__near_ridge_kernel_g3oo
standalone__mha_block_cached__near_ridge_kernel_g3d:
    s_lshl_b32 s62, s3, 3
    s_add_u32 s62, s62, 64
    s_lshl_b32 s33, s4, 9
    s_add_u32 s33, s33, s62
    s_lshl_b32 s33, s33, 10
    s_add_u32 s36, s33, 0
    s_add_u32 s37, s33, 131072
    s_add_u32 s38, s33, 262144
    s_add_u32 s39, s33, 393216
    s_mul_i32 s33, s5, 640
    s_add_u32 s33, s33, s62
    s_lshl_b32 s33, s33, 10
    s_add_u32 s40, s33, 25165824
    s_add_u32 s41, s33, 25296896
    s_add_u32 s42, s33, 25427968
    s_add_u32 s43, s33, 25559040
    s_add_u32 s46, s33, 25690112
    buffer_load_dwordx4 v[180:183], v2, s[24:27], s40 offen sc1
    buffer_load_dwordx4 v[184:187], v2, s[24:27], s41 offen sc1
    buffer_load_dwordx4 v[188:191], v2, s[24:27], s42 offen sc1
    buffer_load_dwordx4 v[192:195], v2, s[24:27], s43 offen sc1
    buffer_load_dwordx4 v[196:199], v2, s[24:27], s46 offen sc1
    buffer_load_dwordx4 v[200:203], v2, s[24:27], s36 offen sc1
    buffer_load_dwordx4 v[204:207], v2, s[24:27], s37 offen sc1
    buffer_load_dwordx4 v[208:211], v2, s[24:27], s38 offen sc1
    buffer_load_dwordx4 v[212:215], v2, s[24:27], s39 offen sc1
    s_waitcnt vmcnt(21)
    v_mfma_f32_16x16x32_bf16 v[64:67], v[216:219], v[236:239], v[64:67]
    s_waitcnt vmcnt(20)
    v_mfma_f32_16x16x32_bf16 v[68:71], v[216:219], v[240:243], v[68:71]
    s_waitcnt vmcnt(19)
    v_mfma_f32_16x16x32_bf16 v[72:75], v[216:219], v[244:247], v[72:75]
    s_waitcnt vmcnt(18)
    v_mfma_f32_16x16x32_bf16 v[76:79], v[216:219], v[248:251], v[76:79]
    v_mfma_f32_16x16x32_bf16 v[80:83], v[220:223], v[236:239], v[80:83]
    v_mfma_f32_16x16x32_bf16 v[84:87], v[220:223], v[240:243], v[84:87]
    v_mfma_f32_16x16x32_bf16 v[88:91], v[220:223], v[244:247], v[88:91]
    v_mfma_f32_16x16x32_bf16 v[92:95], v[220:223], v[248:251], v[92:95]
    v_mfma_f32_16x16x32_bf16 v[96:99], v[224:227], v[236:239], v[96:99]
    v_mfma_f32_16x16x32_bf16 v[100:103], v[224:227], v[240:243], v[100:103]
    v_mfma_f32_16x16x32_bf16 v[104:107], v[224:227], v[244:247], v[104:107]
    v_mfma_f32_16x16x32_bf16 v[108:111], v[224:227], v[248:251], v[108:111]
    v_mfma_f32_16x16x32_bf16 v[112:115], v[228:231], v[236:239], v[112:115]
    v_mfma_f32_16x16x32_bf16 v[116:119], v[228:231], v[240:243], v[116:119]
    v_mfma_f32_16x16x32_bf16 v[120:123], v[228:231], v[244:247], v[120:123]
    v_mfma_f32_16x16x32_bf16 v[124:127], v[228:231], v[248:251], v[124:127]
    v_mfma_f32_16x16x32_bf16 v[128:131], v[232:235], v[236:239], v[128:131]
    v_mfma_f32_16x16x32_bf16 v[132:135], v[232:235], v[240:243], v[132:135]
    v_mfma_f32_16x16x32_bf16 v[136:139], v[232:235], v[244:247], v[136:139]
    v_mfma_f32_16x16x32_bf16 v[140:143], v[232:235], v[248:251], v[140:143]
    buffer_load_dwordx4 v[216:219], v2, s[24:27], s40 offen offset:1024 sc1
    buffer_load_dwordx4 v[220:223], v2, s[24:27], s41 offen offset:1024 sc1
    buffer_load_dwordx4 v[224:227], v2, s[24:27], s42 offen offset:1024 sc1
    buffer_load_dwordx4 v[228:231], v2, s[24:27], s43 offen offset:1024 sc1
    buffer_load_dwordx4 v[232:235], v2, s[24:27], s46 offen offset:1024 sc1
    buffer_load_dwordx4 v[236:239], v2, s[24:27], s36 offen offset:1024 sc1
    buffer_load_dwordx4 v[240:243], v2, s[24:27], s37 offen offset:1024 sc1
    buffer_load_dwordx4 v[244:247], v2, s[24:27], s38 offen offset:1024 sc1
    buffer_load_dwordx4 v[248:251], v2, s[24:27], s39 offen offset:1024 sc1
    s_waitcnt vmcnt(21)
    v_mfma_f32_16x16x32_bf16 v[64:67], v[144:147], v[164:167], v[64:67]
    s_waitcnt vmcnt(20)
    v_mfma_f32_16x16x32_bf16 v[68:71], v[144:147], v[168:171], v[68:71]
    s_waitcnt vmcnt(19)
    v_mfma_f32_16x16x32_bf16 v[72:75], v[144:147], v[172:175], v[72:75]
    s_waitcnt vmcnt(18)
    v_mfma_f32_16x16x32_bf16 v[76:79], v[144:147], v[176:179], v[76:79]
    v_mfma_f32_16x16x32_bf16 v[80:83], v[148:151], v[164:167], v[80:83]
    v_mfma_f32_16x16x32_bf16 v[84:87], v[148:151], v[168:171], v[84:87]
    v_mfma_f32_16x16x32_bf16 v[88:91], v[148:151], v[172:175], v[88:91]
    v_mfma_f32_16x16x32_bf16 v[92:95], v[148:151], v[176:179], v[92:95]
    v_mfma_f32_16x16x32_bf16 v[96:99], v[152:155], v[164:167], v[96:99]
    v_mfma_f32_16x16x32_bf16 v[100:103], v[152:155], v[168:171], v[100:103]
    v_mfma_f32_16x16x32_bf16 v[104:107], v[152:155], v[172:175], v[104:107]
    v_mfma_f32_16x16x32_bf16 v[108:111], v[152:155], v[176:179], v[108:111]
    v_mfma_f32_16x16x32_bf16 v[112:115], v[156:159], v[164:167], v[112:115]
    v_mfma_f32_16x16x32_bf16 v[116:119], v[156:159], v[168:171], v[116:119]
    v_mfma_f32_16x16x32_bf16 v[120:123], v[156:159], v[172:175], v[120:123]
    v_mfma_f32_16x16x32_bf16 v[124:127], v[156:159], v[176:179], v[124:127]
    v_mfma_f32_16x16x32_bf16 v[128:131], v[160:163], v[164:167], v[128:131]
    v_mfma_f32_16x16x32_bf16 v[132:135], v[160:163], v[168:171], v[132:135]
    v_mfma_f32_16x16x32_bf16 v[136:139], v[160:163], v[172:175], v[136:139]
    v_mfma_f32_16x16x32_bf16 v[140:143], v[160:163], v[176:179], v[140:143]
    buffer_load_dwordx4 v[144:147], v2, s[24:27], s40 offen offset:2048 sc1
    buffer_load_dwordx4 v[148:151], v2, s[24:27], s41 offen offset:2048 sc1
    buffer_load_dwordx4 v[152:155], v2, s[24:27], s42 offen offset:2048 sc1
    buffer_load_dwordx4 v[156:159], v2, s[24:27], s43 offen offset:2048 sc1
    buffer_load_dwordx4 v[160:163], v2, s[24:27], s46 offen offset:2048 sc1
    buffer_load_dwordx4 v[164:167], v2, s[24:27], s36 offen offset:2048 sc1
    buffer_load_dwordx4 v[168:171], v2, s[24:27], s37 offen offset:2048 sc1
    buffer_load_dwordx4 v[172:175], v2, s[24:27], s38 offen offset:2048 sc1
    buffer_load_dwordx4 v[176:179], v2, s[24:27], s39 offen offset:2048 sc1
    s_waitcnt vmcnt(21)
    v_mfma_f32_16x16x32_bf16 v[64:67], v[180:183], v[200:203], v[64:67]
    s_waitcnt vmcnt(20)
    v_mfma_f32_16x16x32_bf16 v[68:71], v[180:183], v[204:207], v[68:71]
    s_waitcnt vmcnt(19)
    v_mfma_f32_16x16x32_bf16 v[72:75], v[180:183], v[208:211], v[72:75]
    s_waitcnt vmcnt(18)
    v_mfma_f32_16x16x32_bf16 v[76:79], v[180:183], v[212:215], v[76:79]
    v_mfma_f32_16x16x32_bf16 v[80:83], v[184:187], v[200:203], v[80:83]
    v_mfma_f32_16x16x32_bf16 v[84:87], v[184:187], v[204:207], v[84:87]
    v_mfma_f32_16x16x32_bf16 v[88:91], v[184:187], v[208:211], v[88:91]
    v_mfma_f32_16x16x32_bf16 v[92:95], v[184:187], v[212:215], v[92:95]
    v_mfma_f32_16x16x32_bf16 v[96:99], v[188:191], v[200:203], v[96:99]
    v_mfma_f32_16x16x32_bf16 v[100:103], v[188:191], v[204:207], v[100:103]
    v_mfma_f32_16x16x32_bf16 v[104:107], v[188:191], v[208:211], v[104:107]
    v_mfma_f32_16x16x32_bf16 v[108:111], v[188:191], v[212:215], v[108:111]
    v_mfma_f32_16x16x32_bf16 v[112:115], v[192:195], v[200:203], v[112:115]
    v_mfma_f32_16x16x32_bf16 v[116:119], v[192:195], v[204:207], v[116:119]
    v_mfma_f32_16x16x32_bf16 v[120:123], v[192:195], v[208:211], v[120:123]
    v_mfma_f32_16x16x32_bf16 v[124:127], v[192:195], v[212:215], v[124:127]
    v_mfma_f32_16x16x32_bf16 v[128:131], v[196:199], v[200:203], v[128:131]
    v_mfma_f32_16x16x32_bf16 v[132:135], v[196:199], v[204:207], v[132:135]
    v_mfma_f32_16x16x32_bf16 v[136:139], v[196:199], v[208:211], v[136:139]
    v_mfma_f32_16x16x32_bf16 v[140:143], v[196:199], v[212:215], v[140:143]
    buffer_load_dwordx4 v[180:183], v2, s[24:27], s40 offen offset:3072 sc1
    buffer_load_dwordx4 v[184:187], v2, s[24:27], s41 offen offset:3072 sc1
    buffer_load_dwordx4 v[188:191], v2, s[24:27], s42 offen offset:3072 sc1
    buffer_load_dwordx4 v[192:195], v2, s[24:27], s43 offen offset:3072 sc1
    buffer_load_dwordx4 v[196:199], v2, s[24:27], s46 offen offset:3072 sc1
    buffer_load_dwordx4 v[200:203], v2, s[24:27], s36 offen offset:3072 sc1
    buffer_load_dwordx4 v[204:207], v2, s[24:27], s37 offen offset:3072 sc1
    buffer_load_dwordx4 v[208:211], v2, s[24:27], s38 offen offset:3072 sc1
    buffer_load_dwordx4 v[212:215], v2, s[24:27], s39 offen offset:3072 sc1
    s_waitcnt vmcnt(21)
    v_mfma_f32_16x16x32_bf16 v[64:67], v[216:219], v[236:239], v[64:67]
    s_waitcnt vmcnt(20)
    v_mfma_f32_16x16x32_bf16 v[68:71], v[216:219], v[240:243], v[68:71]
    s_waitcnt vmcnt(19)
    v_mfma_f32_16x16x32_bf16 v[72:75], v[216:219], v[244:247], v[72:75]
    s_waitcnt vmcnt(18)
    v_mfma_f32_16x16x32_bf16 v[76:79], v[216:219], v[248:251], v[76:79]
    v_mfma_f32_16x16x32_bf16 v[80:83], v[220:223], v[236:239], v[80:83]
    v_mfma_f32_16x16x32_bf16 v[84:87], v[220:223], v[240:243], v[84:87]
    v_mfma_f32_16x16x32_bf16 v[88:91], v[220:223], v[244:247], v[88:91]
    v_mfma_f32_16x16x32_bf16 v[92:95], v[220:223], v[248:251], v[92:95]
    v_mfma_f32_16x16x32_bf16 v[96:99], v[224:227], v[236:239], v[96:99]
    v_mfma_f32_16x16x32_bf16 v[100:103], v[224:227], v[240:243], v[100:103]
    v_mfma_f32_16x16x32_bf16 v[104:107], v[224:227], v[244:247], v[104:107]
    v_mfma_f32_16x16x32_bf16 v[108:111], v[224:227], v[248:251], v[108:111]
    v_mfma_f32_16x16x32_bf16 v[112:115], v[228:231], v[236:239], v[112:115]
    v_mfma_f32_16x16x32_bf16 v[116:119], v[228:231], v[240:243], v[116:119]
    v_mfma_f32_16x16x32_bf16 v[120:123], v[228:231], v[244:247], v[120:123]
    v_mfma_f32_16x16x32_bf16 v[124:127], v[228:231], v[248:251], v[124:127]
    v_mfma_f32_16x16x32_bf16 v[128:131], v[232:235], v[236:239], v[128:131]
    v_mfma_f32_16x16x32_bf16 v[132:135], v[232:235], v[240:243], v[132:135]
    v_mfma_f32_16x16x32_bf16 v[136:139], v[232:235], v[244:247], v[136:139]
    v_mfma_f32_16x16x32_bf16 v[140:143], v[232:235], v[248:251], v[140:143]
    buffer_load_dwordx4 v[216:219], v3, s[24:27], s40 offen sc1
    buffer_load_dwordx4 v[220:223], v3, s[24:27], s41 offen sc1
    buffer_load_dwordx4 v[224:227], v3, s[24:27], s42 offen sc1
    buffer_load_dwordx4 v[228:231], v3, s[24:27], s43 offen sc1
    buffer_load_dwordx4 v[232:235], v3, s[24:27], s46 offen sc1
    buffer_load_dwordx4 v[236:239], v3, s[24:27], s36 offen sc1
    buffer_load_dwordx4 v[240:243], v3, s[24:27], s37 offen sc1
    buffer_load_dwordx4 v[244:247], v3, s[24:27], s38 offen sc1
    buffer_load_dwordx4 v[248:251], v3, s[24:27], s39 offen sc1
    s_waitcnt vmcnt(21)
    v_mfma_f32_16x16x32_bf16 v[64:67], v[144:147], v[164:167], v[64:67]
    s_waitcnt vmcnt(20)
    v_mfma_f32_16x16x32_bf16 v[68:71], v[144:147], v[168:171], v[68:71]
    s_waitcnt vmcnt(19)
    v_mfma_f32_16x16x32_bf16 v[72:75], v[144:147], v[172:175], v[72:75]
    s_waitcnt vmcnt(18)
    v_mfma_f32_16x16x32_bf16 v[76:79], v[144:147], v[176:179], v[76:79]
    v_mfma_f32_16x16x32_bf16 v[80:83], v[148:151], v[164:167], v[80:83]
    v_mfma_f32_16x16x32_bf16 v[84:87], v[148:151], v[168:171], v[84:87]
    v_mfma_f32_16x16x32_bf16 v[88:91], v[148:151], v[172:175], v[88:91]
    v_mfma_f32_16x16x32_bf16 v[92:95], v[148:151], v[176:179], v[92:95]
    v_mfma_f32_16x16x32_bf16 v[96:99], v[152:155], v[164:167], v[96:99]
    v_mfma_f32_16x16x32_bf16 v[100:103], v[152:155], v[168:171], v[100:103]
    v_mfma_f32_16x16x32_bf16 v[104:107], v[152:155], v[172:175], v[104:107]
    v_mfma_f32_16x16x32_bf16 v[108:111], v[152:155], v[176:179], v[108:111]
    v_mfma_f32_16x16x32_bf16 v[112:115], v[156:159], v[164:167], v[112:115]
    v_mfma_f32_16x16x32_bf16 v[116:119], v[156:159], v[168:171], v[116:119]
    v_mfma_f32_16x16x32_bf16 v[120:123], v[156:159], v[172:175], v[120:123]
    v_mfma_f32_16x16x32_bf16 v[124:127], v[156:159], v[176:179], v[124:127]
    v_mfma_f32_16x16x32_bf16 v[128:131], v[160:163], v[164:167], v[128:131]
    v_mfma_f32_16x16x32_bf16 v[132:135], v[160:163], v[168:171], v[132:135]
    v_mfma_f32_16x16x32_bf16 v[136:139], v[160:163], v[172:175], v[136:139]
    v_mfma_f32_16x16x32_bf16 v[140:143], v[160:163], v[176:179], v[140:143]
    buffer_load_dwordx4 v[144:147], v3, s[24:27], s40 offen offset:1024 sc1
    buffer_load_dwordx4 v[148:151], v3, s[24:27], s41 offen offset:1024 sc1
    buffer_load_dwordx4 v[152:155], v3, s[24:27], s42 offen offset:1024 sc1
    buffer_load_dwordx4 v[156:159], v3, s[24:27], s43 offen offset:1024 sc1
    buffer_load_dwordx4 v[160:163], v3, s[24:27], s46 offen offset:1024 sc1
    buffer_load_dwordx4 v[164:167], v3, s[24:27], s36 offen offset:1024 sc1
    buffer_load_dwordx4 v[168:171], v3, s[24:27], s37 offen offset:1024 sc1
    buffer_load_dwordx4 v[172:175], v3, s[24:27], s38 offen offset:1024 sc1
    buffer_load_dwordx4 v[176:179], v3, s[24:27], s39 offen offset:1024 sc1
    s_waitcnt vmcnt(21)
    v_mfma_f32_16x16x32_bf16 v[64:67], v[180:183], v[200:203], v[64:67]
    s_waitcnt vmcnt(20)
    v_mfma_f32_16x16x32_bf16 v[68:71], v[180:183], v[204:207], v[68:71]
    s_waitcnt vmcnt(19)
    v_mfma_f32_16x16x32_bf16 v[72:75], v[180:183], v[208:211], v[72:75]
    s_waitcnt vmcnt(18)
    v_mfma_f32_16x16x32_bf16 v[76:79], v[180:183], v[212:215], v[76:79]
    v_mfma_f32_16x16x32_bf16 v[80:83], v[184:187], v[200:203], v[80:83]
    v_mfma_f32_16x16x32_bf16 v[84:87], v[184:187], v[204:207], v[84:87]
    v_mfma_f32_16x16x32_bf16 v[88:91], v[184:187], v[208:211], v[88:91]
    v_mfma_f32_16x16x32_bf16 v[92:95], v[184:187], v[212:215], v[92:95]
    v_mfma_f32_16x16x32_bf16 v[96:99], v[188:191], v[200:203], v[96:99]
    v_mfma_f32_16x16x32_bf16 v[100:103], v[188:191], v[204:207], v[100:103]
    v_mfma_f32_16x16x32_bf16 v[104:107], v[188:191], v[208:211], v[104:107]
    v_mfma_f32_16x16x32_bf16 v[108:111], v[188:191], v[212:215], v[108:111]
    v_mfma_f32_16x16x32_bf16 v[112:115], v[192:195], v[200:203], v[112:115]
    v_mfma_f32_16x16x32_bf16 v[116:119], v[192:195], v[204:207], v[116:119]
    v_mfma_f32_16x16x32_bf16 v[120:123], v[192:195], v[208:211], v[120:123]
    v_mfma_f32_16x16x32_bf16 v[124:127], v[192:195], v[212:215], v[124:127]
    v_mfma_f32_16x16x32_bf16 v[128:131], v[196:199], v[200:203], v[128:131]
    v_mfma_f32_16x16x32_bf16 v[132:135], v[196:199], v[204:207], v[132:135]
    v_mfma_f32_16x16x32_bf16 v[136:139], v[196:199], v[208:211], v[136:139]
    v_mfma_f32_16x16x32_bf16 v[140:143], v[196:199], v[212:215], v[140:143]
    buffer_load_dwordx4 v[180:183], v3, s[24:27], s40 offen offset:2048 sc1
    buffer_load_dwordx4 v[184:187], v3, s[24:27], s41 offen offset:2048 sc1
    buffer_load_dwordx4 v[188:191], v3, s[24:27], s42 offen offset:2048 sc1
    buffer_load_dwordx4 v[192:195], v3, s[24:27], s43 offen offset:2048 sc1
    buffer_load_dwordx4 v[196:199], v3, s[24:27], s46 offen offset:2048 sc1
    buffer_load_dwordx4 v[200:203], v3, s[24:27], s36 offen offset:2048 sc1
    buffer_load_dwordx4 v[204:207], v3, s[24:27], s37 offen offset:2048 sc1
    buffer_load_dwordx4 v[208:211], v3, s[24:27], s38 offen offset:2048 sc1
    buffer_load_dwordx4 v[212:215], v3, s[24:27], s39 offen offset:2048 sc1
    s_waitcnt vmcnt(21)
    v_mfma_f32_16x16x32_bf16 v[64:67], v[216:219], v[236:239], v[64:67]
    s_waitcnt vmcnt(20)
    v_mfma_f32_16x16x32_bf16 v[68:71], v[216:219], v[240:243], v[68:71]
    s_waitcnt vmcnt(19)
    v_mfma_f32_16x16x32_bf16 v[72:75], v[216:219], v[244:247], v[72:75]
    s_waitcnt vmcnt(18)
    v_mfma_f32_16x16x32_bf16 v[76:79], v[216:219], v[248:251], v[76:79]
    v_mfma_f32_16x16x32_bf16 v[80:83], v[220:223], v[236:239], v[80:83]
    v_mfma_f32_16x16x32_bf16 v[84:87], v[220:223], v[240:243], v[84:87]
    v_mfma_f32_16x16x32_bf16 v[88:91], v[220:223], v[244:247], v[88:91]
    v_mfma_f32_16x16x32_bf16 v[92:95], v[220:223], v[248:251], v[92:95]
    v_mfma_f32_16x16x32_bf16 v[96:99], v[224:227], v[236:239], v[96:99]
    v_mfma_f32_16x16x32_bf16 v[100:103], v[224:227], v[240:243], v[100:103]
    v_mfma_f32_16x16x32_bf16 v[104:107], v[224:227], v[244:247], v[104:107]
    v_mfma_f32_16x16x32_bf16 v[108:111], v[224:227], v[248:251], v[108:111]
    v_mfma_f32_16x16x32_bf16 v[112:115], v[228:231], v[236:239], v[112:115]
    v_mfma_f32_16x16x32_bf16 v[116:119], v[228:231], v[240:243], v[116:119]
    v_mfma_f32_16x16x32_bf16 v[120:123], v[228:231], v[244:247], v[120:123]
    v_mfma_f32_16x16x32_bf16 v[124:127], v[228:231], v[248:251], v[124:127]
    v_mfma_f32_16x16x32_bf16 v[128:131], v[232:235], v[236:239], v[128:131]
    v_mfma_f32_16x16x32_bf16 v[132:135], v[232:235], v[240:243], v[132:135]
    v_mfma_f32_16x16x32_bf16 v[136:139], v[232:235], v[244:247], v[136:139]
    v_mfma_f32_16x16x32_bf16 v[140:143], v[232:235], v[248:251], v[140:143]
    buffer_load_dwordx4 v[216:219], v3, s[24:27], s40 offen offset:3072 sc1
    buffer_load_dwordx4 v[220:223], v3, s[24:27], s41 offen offset:3072 sc1
    buffer_load_dwordx4 v[224:227], v3, s[24:27], s42 offen offset:3072 sc1
    buffer_load_dwordx4 v[228:231], v3, s[24:27], s43 offen offset:3072 sc1
    buffer_load_dwordx4 v[232:235], v3, s[24:27], s46 offen offset:3072 sc1
    buffer_load_dwordx4 v[236:239], v3, s[24:27], s36 offen offset:3072 sc1
    buffer_load_dwordx4 v[240:243], v3, s[24:27], s37 offen offset:3072 sc1
    buffer_load_dwordx4 v[244:247], v3, s[24:27], s38 offen offset:3072 sc1
    buffer_load_dwordx4 v[248:251], v3, s[24:27], s39 offen offset:3072 sc1
    s_waitcnt vmcnt(21)
    v_mfma_f32_16x16x32_bf16 v[64:67], v[144:147], v[164:167], v[64:67]
    s_waitcnt vmcnt(20)
    v_mfma_f32_16x16x32_bf16 v[68:71], v[144:147], v[168:171], v[68:71]
    s_waitcnt vmcnt(19)
    v_mfma_f32_16x16x32_bf16 v[72:75], v[144:147], v[172:175], v[72:75]
    s_waitcnt vmcnt(18)
    v_mfma_f32_16x16x32_bf16 v[76:79], v[144:147], v[176:179], v[76:79]
    v_mfma_f32_16x16x32_bf16 v[80:83], v[148:151], v[164:167], v[80:83]
    v_mfma_f32_16x16x32_bf16 v[84:87], v[148:151], v[168:171], v[84:87]
    v_mfma_f32_16x16x32_bf16 v[88:91], v[148:151], v[172:175], v[88:91]
    v_mfma_f32_16x16x32_bf16 v[92:95], v[148:151], v[176:179], v[92:95]
    v_mfma_f32_16x16x32_bf16 v[96:99], v[152:155], v[164:167], v[96:99]
    v_mfma_f32_16x16x32_bf16 v[100:103], v[152:155], v[168:171], v[100:103]
    v_mfma_f32_16x16x32_bf16 v[104:107], v[152:155], v[172:175], v[104:107]
    v_mfma_f32_16x16x32_bf16 v[108:111], v[152:155], v[176:179], v[108:111]
    v_mfma_f32_16x16x32_bf16 v[112:115], v[156:159], v[164:167], v[112:115]
    v_mfma_f32_16x16x32_bf16 v[116:119], v[156:159], v[168:171], v[116:119]
    v_mfma_f32_16x16x32_bf16 v[120:123], v[156:159], v[172:175], v[120:123]
    v_mfma_f32_16x16x32_bf16 v[124:127], v[156:159], v[176:179], v[124:127]
    v_mfma_f32_16x16x32_bf16 v[128:131], v[160:163], v[164:167], v[128:131]
    v_mfma_f32_16x16x32_bf16 v[132:135], v[160:163], v[168:171], v[132:135]
    v_mfma_f32_16x16x32_bf16 v[136:139], v[160:163], v[172:175], v[136:139]
    v_mfma_f32_16x16x32_bf16 v[140:143], v[160:163], v[176:179], v[140:143]
    s_waitcnt vmcnt(12)
    v_mfma_f32_16x16x32_bf16 v[64:67], v[180:183], v[200:203], v[64:67]
    s_waitcnt vmcnt(11)
    v_mfma_f32_16x16x32_bf16 v[68:71], v[180:183], v[204:207], v[68:71]
    s_waitcnt vmcnt(10)
    v_mfma_f32_16x16x32_bf16 v[72:75], v[180:183], v[208:211], v[72:75]
    s_waitcnt vmcnt(9)
    v_mfma_f32_16x16x32_bf16 v[76:79], v[180:183], v[212:215], v[76:79]
    v_mfma_f32_16x16x32_bf16 v[80:83], v[184:187], v[200:203], v[80:83]
    v_mfma_f32_16x16x32_bf16 v[84:87], v[184:187], v[204:207], v[84:87]
    v_mfma_f32_16x16x32_bf16 v[88:91], v[184:187], v[208:211], v[88:91]
    v_mfma_f32_16x16x32_bf16 v[92:95], v[184:187], v[212:215], v[92:95]
    v_mfma_f32_16x16x32_bf16 v[96:99], v[188:191], v[200:203], v[96:99]
    v_mfma_f32_16x16x32_bf16 v[100:103], v[188:191], v[204:207], v[100:103]
    v_mfma_f32_16x16x32_bf16 v[104:107], v[188:191], v[208:211], v[104:107]
    v_mfma_f32_16x16x32_bf16 v[108:111], v[188:191], v[212:215], v[108:111]
    v_mfma_f32_16x16x32_bf16 v[112:115], v[192:195], v[200:203], v[112:115]
    v_mfma_f32_16x16x32_bf16 v[116:119], v[192:195], v[204:207], v[116:119]
    v_mfma_f32_16x16x32_bf16 v[120:123], v[192:195], v[208:211], v[120:123]
    v_mfma_f32_16x16x32_bf16 v[124:127], v[192:195], v[212:215], v[124:127]
    v_mfma_f32_16x16x32_bf16 v[128:131], v[196:199], v[200:203], v[128:131]
    v_mfma_f32_16x16x32_bf16 v[132:135], v[196:199], v[204:207], v[132:135]
    v_mfma_f32_16x16x32_bf16 v[136:139], v[196:199], v[208:211], v[136:139]
    v_mfma_f32_16x16x32_bf16 v[140:143], v[196:199], v[212:215], v[140:143]
    s_waitcnt vmcnt(3)
    v_mfma_f32_16x16x32_bf16 v[64:67], v[216:219], v[236:239], v[64:67]
    s_waitcnt vmcnt(2)
    v_mfma_f32_16x16x32_bf16 v[68:71], v[216:219], v[240:243], v[68:71]
    s_waitcnt vmcnt(1)
    v_mfma_f32_16x16x32_bf16 v[72:75], v[216:219], v[244:247], v[72:75]
    s_waitcnt vmcnt(0)
    v_mfma_f32_16x16x32_bf16 v[76:79], v[216:219], v[248:251], v[76:79]
    v_mfma_f32_16x16x32_bf16 v[80:83], v[220:223], v[236:239], v[80:83]
    v_mfma_f32_16x16x32_bf16 v[84:87], v[220:223], v[240:243], v[84:87]
    v_mfma_f32_16x16x32_bf16 v[88:91], v[220:223], v[244:247], v[88:91]
    v_mfma_f32_16x16x32_bf16 v[92:95], v[220:223], v[248:251], v[92:95]
    v_mfma_f32_16x16x32_bf16 v[96:99], v[224:227], v[236:239], v[96:99]
    v_mfma_f32_16x16x32_bf16 v[100:103], v[224:227], v[240:243], v[100:103]
    v_mfma_f32_16x16x32_bf16 v[104:107], v[224:227], v[244:247], v[104:107]
    v_mfma_f32_16x16x32_bf16 v[108:111], v[224:227], v[248:251], v[108:111]
    v_mfma_f32_16x16x32_bf16 v[112:115], v[228:231], v[236:239], v[112:115]
    v_mfma_f32_16x16x32_bf16 v[116:119], v[228:231], v[240:243], v[116:119]
    v_mfma_f32_16x16x32_bf16 v[120:123], v[228:231], v[244:247], v[120:123]
    v_mfma_f32_16x16x32_bf16 v[124:127], v[228:231], v[248:251], v[124:127]
    v_mfma_f32_16x16x32_bf16 v[128:131], v[232:235], v[236:239], v[128:131]
    v_mfma_f32_16x16x32_bf16 v[132:135], v[232:235], v[240:243], v[132:135]
    v_mfma_f32_16x16x32_bf16 v[136:139], v[232:235], v[244:247], v[136:139]
    v_mfma_f32_16x16x32_bf16 v[140:143], v[232:235], v[248:251], v[140:143]
standalone__mha_block_cached__near_ridge_kernel_Tred:
    s_nop 7
    s_barrier
    s_mul_i32 s33, s3, 20480
    v_add_u32 v8, s33, v2
    ds_write_b128 v8, v[64:67]
    ds_write_b128 v8, v[68:71] offset:1024
    ds_write_b128 v8, v[72:75] offset:2048
    ds_write_b128 v8, v[76:79] offset:3072
    ds_write_b128 v8, v[80:83] offset:4096
    ds_write_b128 v8, v[84:87] offset:5120
    ds_write_b128 v8, v[88:91] offset:6144
    ds_write_b128 v8, v[92:95] offset:7168
    ds_write_b128 v8, v[96:99] offset:8192
    ds_write_b128 v8, v[100:103] offset:9216
    ds_write_b128 v8, v[104:107] offset:10240
    ds_write_b128 v8, v[108:111] offset:11264
    ds_write_b128 v8, v[112:115] offset:12288
    ds_write_b128 v8, v[116:119] offset:13312
    ds_write_b128 v8, v[120:123] offset:14336
    s_waitcnt lgkmcnt(14)
    ds_write_b128 v8, v[124:127] offset:15360
    s_waitcnt lgkmcnt(14)
    ds_write_b128 v8, v[128:131] offset:16384
    s_waitcnt lgkmcnt(14)
    ds_write_b128 v8, v[132:135] offset:17408
    s_waitcnt lgkmcnt(14)
    ds_write_b128 v8, v[136:139] offset:18432
    s_waitcnt lgkmcnt(14)
    ds_write_b128 v8, v[140:143] offset:19456
    s_waitcnt lgkmcnt(0)
    s_barrier
    v_and_b32 v9, 15, v0
    v_mul_u32_u24 v9, 1280, v9
    v_lshrrev_b32 v10, 4, v0
    v_lshl_add_u32 v9, v10, 3, v9
    s_mul_i32 s34, s4, 81920
    s_mul_i32 s33, s5, 160
    s_add_u32 s34, s34, s33
    s_lshl_b32 s35, s3, 10
    v_add_u32 v11, s35, v2
    s_add_u32 s40, s3, 0
    s_lshr_b32 s41, s40, 2
    s_and_b32 s42, s40, 3
    s_lshl_b32 s41, s41, 5
    s_mul_i32 s42, s42, 20480
    s_add_u32 s41, s41, s42
    s_add_u32 s41, s41, s34
    ds_read_b128 v[64:67], v11
    ds_read_b128 v[68:71], v11 offset:20480
    ds_read_b128 v[72:75], v11 offset:40960
    ds_read_b128 v[76:79], v11 offset:61440
    v_add_u32 v12, 81920, v11
    ds_read_b128 v[80:83], v12
    v_add_u32 v12, 102400, v11
    ds_read_b128 v[84:87], v12
    v_add_u32 v12, 122880, v11
    ds_read_b128 v[88:91], v12
    v_add_u32 v12, 143360, v11
    ds_read_b128 v[92:95], v12
    s_waitcnt lgkmcnt(6)
    v_add_f32 v64, v64, v68
    v_add_f32 v65, v65, v69
    v_add_f32 v66, v66, v70
    v_add_f32 v67, v67, v71
    s_waitcnt lgkmcnt(5)
    v_add_f32 v64, v64, v72
    v_add_f32 v65, v65, v73
    v_add_f32 v66, v66, v74
    v_add_f32 v67, v67, v75
    s_waitcnt lgkmcnt(4)
    v_add_f32 v64, v64, v76
    v_add_f32 v65, v65, v77
    v_add_f32 v66, v66, v78
    v_add_f32 v67, v67, v79
    s_waitcnt lgkmcnt(3)
    v_add_f32 v64, v64, v80
    v_add_f32 v65, v65, v81
    v_add_f32 v66, v66, v82
    v_add_f32 v67, v67, v83
    s_waitcnt lgkmcnt(2)
    v_add_f32 v64, v64, v84
    v_add_f32 v65, v65, v85
    v_add_f32 v66, v66, v86
    v_add_f32 v67, v67, v87
    s_waitcnt lgkmcnt(1)
    v_add_f32 v64, v64, v88
    v_add_f32 v65, v65, v89
    v_add_f32 v66, v66, v90
    v_add_f32 v67, v67, v91
    s_waitcnt lgkmcnt(0)
    v_add_f32 v64, v64, v92
    v_add_f32 v65, v65, v93
    v_add_f32 v66, v66, v94
    v_add_f32 v67, v67, v95
    v_cvt_pk_bf16_f32 v104, v64, v65
    v_cvt_pk_bf16_f32 v105, v66, v67
    buffer_store_dwordx2 v[104:105], v9, s[20:23], s41 offen
    s_nop 1
    s_add_u32 s40, s3, 8
    s_lshr_b32 s41, s40, 2
    s_and_b32 s42, s40, 3
    s_lshl_b32 s41, s41, 5
    s_mul_i32 s42, s42, 20480
    s_add_u32 s41, s41, s42
    s_add_u32 s41, s41, s34
    ds_read_b128 v[64:67], v11 offset:8192
    ds_read_b128 v[68:71], v11 offset:28672
    ds_read_b128 v[72:75], v11 offset:49152
    v_add_u32 v12, 69632, v11
    ds_read_b128 v[76:79], v12
    v_add_u32 v12, 90112, v11
    ds_read_b128 v[80:83], v12
    v_add_u32 v12, 110592, v11
    ds_read_b128 v[84:87], v12
    v_add_u32 v12, 131072, v11
    ds_read_b128 v[88:91], v12
    v_add_u32 v12, 151552, v11
    ds_read_b128 v[92:95], v12
    s_waitcnt lgkmcnt(6)
    v_add_f32 v64, v64, v68
    v_add_f32 v65, v65, v69
    v_add_f32 v66, v66, v70
    v_add_f32 v67, v67, v71
    s_waitcnt lgkmcnt(5)
    v_add_f32 v64, v64, v72
    v_add_f32 v65, v65, v73
    v_add_f32 v66, v66, v74
    v_add_f32 v67, v67, v75
    s_waitcnt lgkmcnt(4)
    v_add_f32 v64, v64, v76
    v_add_f32 v65, v65, v77
    v_add_f32 v66, v66, v78
    v_add_f32 v67, v67, v79
    s_waitcnt lgkmcnt(3)
    v_add_f32 v64, v64, v80
    v_add_f32 v65, v65, v81
    v_add_f32 v66, v66, v82
    v_add_f32 v67, v67, v83
    s_waitcnt lgkmcnt(2)
    v_add_f32 v64, v64, v84
    v_add_f32 v65, v65, v85
    v_add_f32 v66, v66, v86
    v_add_f32 v67, v67, v87
    s_waitcnt lgkmcnt(1)
    v_add_f32 v64, v64, v88
    v_add_f32 v65, v65, v89
    v_add_f32 v66, v66, v90
    v_add_f32 v67, v67, v91
    s_waitcnt lgkmcnt(0)
    v_add_f32 v64, v64, v92
    v_add_f32 v65, v65, v93
    v_add_f32 v66, v66, v94
    v_add_f32 v67, v67, v95
    v_cvt_pk_bf16_f32 v104, v64, v65
    v_cvt_pk_bf16_f32 v105, v66, v67
    buffer_store_dwordx2 v[104:105], v9, s[20:23], s41 offen
    s_nop 1
    s_cmp_ge_u32 s3, 4
    s_cbranch_scc1 standalone__mha_block_cached__near_ridge_kernel_fin
    s_add_u32 s40, s3, 16
    s_lshr_b32 s41, s40, 2
    s_and_b32 s42, s40, 3
    s_lshl_b32 s41, s41, 5
    s_mul_i32 s42, s42, 20480
    s_add_u32 s41, s41, s42
    s_add_u32 s41, s41, s34
    ds_read_b128 v[64:67], v11 offset:16384
    ds_read_b128 v[68:71], v11 offset:36864
    ds_read_b128 v[72:75], v11 offset:57344
    v_add_u32 v12, 77824, v11
    ds_read_b128 v[76:79], v12
    v_add_u32 v12, 98304, v11
    ds_read_b128 v[80:83], v12
    v_add_u32 v12, 118784, v11
    ds_read_b128 v[84:87], v12
    v_add_u32 v12, 139264, v11
    ds_read_b128 v[88:91], v12
    v_add_u32 v12, 159744, v11
    ds_read_b128 v[92:95], v12
    s_waitcnt lgkmcnt(6)
    v_add_f32 v64, v64, v68
    v_add_f32 v65, v65, v69
    v_add_f32 v66, v66, v70
    v_add_f32 v67, v67, v71
    s_waitcnt lgkmcnt(5)
    v_add_f32 v64, v64, v72
    v_add_f32 v65, v65, v73
    v_add_f32 v66, v66, v74
    v_add_f32 v67, v67, v75
    s_waitcnt lgkmcnt(4)
    v_add_f32 v64, v64, v76
    v_add_f32 v65, v65, v77
    v_add_f32 v66, v66, v78
    v_add_f32 v67, v67, v79
    s_waitcnt lgkmcnt(3)
    v_add_f32 v64, v64, v80
    v_add_f32 v65, v65, v81
    v_add_f32 v66, v66, v82
    v_add_f32 v67, v67, v83
    s_waitcnt lgkmcnt(2)
    v_add_f32 v64, v64, v84
    v_add_f32 v65, v65, v85
    v_add_f32 v66, v66, v86
    v_add_f32 v67, v67, v87
    s_waitcnt lgkmcnt(1)
    v_add_f32 v64, v64, v88
    v_add_f32 v65, v65, v89
    v_add_f32 v66, v66, v90
    v_add_f32 v67, v67, v91
    s_waitcnt lgkmcnt(0)
    v_add_f32 v64, v64, v92
    v_add_f32 v65, v65, v93
    v_add_f32 v66, v66, v94
    v_add_f32 v67, v67, v95
    v_cvt_pk_bf16_f32 v104, v64, v65
    v_cvt_pk_bf16_f32 v105, v66, v67
    buffer_store_dwordx2 v[104:105], v9, s[20:23], s41 offen
    s_nop 1
standalone__mha_block_cached__near_ridge_kernel_fin:
    s_branch standalone__mha_block_cached__near_ridge_kernel_done
standalone__mha_block_cached__near_ridge_kernel_Aslow:
    s_nop 0
    s_mov_b32 s8, s38
    s_and_b32 s9, s39, 0xffff
    s_mov_b32 s10, 0x8000000
    s_mov_b32 s11, 0x20000
    s_mov_b32 s12, s40
    s_and_b32 s13, s41, 0xffff
    s_mov_b32 s14, 0x8000000
    s_mov_b32 s15, 0x20000
    s_lshl_b32 s36, s7, 5
    s_add_u32 s36, s36, s6
    s_lshl_b32 s33, s46, 4
    s_add_u32 s36, s36, s33
    s_lshl_b32 s36, s36, 18
    v_mbcnt_lo_u32_b32 v9, -1, 0
    v_mbcnt_hi_u32_b32 v9, -1, v9
    v_and_b32 v10, 31, v9
    v_lshrrev_b32 v9, 5, v9
    v_lshlrev_b32 v7, 8, v10
    v_lshl_add_u32 v7, v9, 4, v7
    v_lshlrev_b32 v8, 1, v10
    v_lshl_add_u32 v8, v9, 10, v8
    v_mov_b32 v64, 0
    v_mov_b32 v65, 0
    v_mov_b32 v66, 0
    v_mov_b32 v67, 0
    v_mov_b32 v68, 0
    v_mov_b32 v69, 0
    v_mov_b32 v70, 0
    v_mov_b32 v71, 0
    v_mov_b32 v72, 0
    v_mov_b32 v73, 0
    v_mov_b32 v74, 0
    v_mov_b32 v75, 0
    v_mov_b32 v76, 0
    v_mov_b32 v77, 0
    v_mov_b32 v78, 0
    v_mov_b32 v79, 0
    v_mov_b32 v80, 0
    v_mov_b32 v81, 0
    v_mov_b32 v82, 0
    v_mov_b32 v83, 0
    v_mov_b32 v84, 0
    v_mov_b32 v85, 0
    v_mov_b32 v86, 0
    v_mov_b32 v87, 0
    v_mov_b32 v88, 0
    v_mov_b32 v89, 0
    v_mov_b32 v90, 0
    v_mov_b32 v91, 0
    v_mov_b32 v92, 0
    v_mov_b32 v93, 0
    v_mov_b32 v94, 0
    v_mov_b32 v95, 0
    v_mov_b32 v96, 0
    v_mov_b32 v97, 0
    v_mov_b32 v98, 0
    v_mov_b32 v99, 0
    v_mov_b32 v100, 0
    v_mov_b32 v101, 0
    v_mov_b32 v102, 0
    v_mov_b32 v103, 0
    v_mov_b32 v104, 0
    v_mov_b32 v105, 0
    v_mov_b32 v106, 0
    v_mov_b32 v107, 0
    v_mov_b32 v108, 0
    v_mov_b32 v109, 0
    v_mov_b32 v110, 0
    v_mov_b32 v111, 0
    v_mov_b32 v112, 0
    v_mov_b32 v113, 0
    v_mov_b32 v114, 0
    v_mov_b32 v115, 0
    v_mov_b32 v116, 0
    v_mov_b32 v117, 0
    v_mov_b32 v118, 0
    v_mov_b32 v119, 0
    v_mov_b32 v120, 0
    v_mov_b32 v121, 0
    v_mov_b32 v122, 0
    v_mov_b32 v123, 0
    v_mov_b32 v124, 0
    v_mov_b32 v125, 0
    v_mov_b32 v126, 0
    v_mov_b32 v127, 0
    v_mov_b32 v2, 0
    v_mov_b32 v5, 0xff7fffff
    s_mov_b32 s37, 0
standalone__mha_block_cached__near_ridge_kernel_Asl:
    buffer_load_dwordx4 v[176:179], v7, s[8:11], s36 offen
    buffer_load_dwordx4 v[180:183], v7, s[8:11], s36 offen offset:32
    buffer_load_dwordx4 v[184:187], v7, s[8:11], s36 offen offset:64
    buffer_load_dwordx4 v[188:191], v7, s[8:11], s36 offen offset:96
    buffer_load_dwordx4 v[192:195], v7, s[8:11], s36 offen offset:128
    buffer_load_dwordx4 v[196:199], v7, s[8:11], s36 offen offset:160
    buffer_load_dwordx4 v[200:203], v7, s[8:11], s36 offen offset:192
    buffer_load_dwordx4 v[204:207], v7, s[8:11], s36 offen offset:224
    s_add_u32 s33, s36, 0
    buffer_load_ushort v144, v8, s[12:15], s33 offen
    s_add_u32 s33, s36, 256
    buffer_load_ushort v145, v8, s[12:15], s33 offen
    s_add_u32 s33, s36, 512
    buffer_load_ushort v146, v8, s[12:15], s33 offen
    s_add_u32 s33, s36, 768
    buffer_load_ushort v147, v8, s[12:15], s33 offen
    s_add_u32 s33, s36, 2048
    buffer_load_ushort v148, v8, s[12:15], s33 offen
    s_add_u32 s33, s36, 2304
    buffer_load_ushort v149, v8, s[12:15], s33 offen
    s_add_u32 s33, s36, 2560
    buffer_load_ushort v150, v8, s[12:15], s33 offen
    s_add_u32 s33, s36, 2816
    buffer_load_ushort v151, v8, s[12:15], s33 offen
    s_add_u32 s33, s36, 64
    buffer_load_ushort v152, v8, s[12:15], s33 offen
    s_add_u32 s33, s36, 320
    buffer_load_ushort v153, v8, s[12:15], s33 offen
    s_add_u32 s33, s36, 576
    buffer_load_ushort v154, v8, s[12:15], s33 offen
    s_add_u32 s33, s36, 832
    buffer_load_ushort v155, v8, s[12:15], s33 offen
    s_add_u32 s33, s36, 2112
    buffer_load_ushort v156, v8, s[12:15], s33 offen
    s_add_u32 s33, s36, 2368
    buffer_load_ushort v157, v8, s[12:15], s33 offen
    s_add_u32 s33, s36, 2624
    buffer_load_ushort v158, v8, s[12:15], s33 offen
    s_add_u32 s33, s36, 2880
    buffer_load_ushort v159, v8, s[12:15], s33 offen
    s_waitcnt vmcnt(0)
    v_lshl_or_b32 v208, v145, 16, v144
    v_lshl_or_b32 v209, v147, 16, v146
    v_lshl_or_b32 v210, v149, 16, v148
    v_lshl_or_b32 v211, v151, 16, v150
    v_lshl_or_b32 v212, v153, 16, v152
    v_lshl_or_b32 v213, v155, 16, v154
    v_lshl_or_b32 v214, v157, 16, v156
    v_lshl_or_b32 v215, v159, 16, v158
    s_add_u32 s33, s36, 128
    buffer_load_ushort v144, v8, s[12:15], s33 offen
    s_add_u32 s33, s36, 384
    buffer_load_ushort v145, v8, s[12:15], s33 offen
    s_add_u32 s33, s36, 640
    buffer_load_ushort v146, v8, s[12:15], s33 offen
    s_add_u32 s33, s36, 896
    buffer_load_ushort v147, v8, s[12:15], s33 offen
    s_add_u32 s33, s36, 2176
    buffer_load_ushort v148, v8, s[12:15], s33 offen
    s_add_u32 s33, s36, 2432
    buffer_load_ushort v149, v8, s[12:15], s33 offen
    s_add_u32 s33, s36, 2688
    buffer_load_ushort v150, v8, s[12:15], s33 offen
    s_add_u32 s33, s36, 2944
    buffer_load_ushort v151, v8, s[12:15], s33 offen
    s_add_u32 s33, s36, 192
    buffer_load_ushort v152, v8, s[12:15], s33 offen
    s_add_u32 s33, s36, 448
    buffer_load_ushort v153, v8, s[12:15], s33 offen
    s_add_u32 s33, s36, 704
    buffer_load_ushort v154, v8, s[12:15], s33 offen
    s_add_u32 s33, s36, 960
    buffer_load_ushort v155, v8, s[12:15], s33 offen
    s_add_u32 s33, s36, 2240
    buffer_load_ushort v156, v8, s[12:15], s33 offen
    s_add_u32 s33, s36, 2496
    buffer_load_ushort v157, v8, s[12:15], s33 offen
    s_add_u32 s33, s36, 2752
    buffer_load_ushort v158, v8, s[12:15], s33 offen
    s_add_u32 s33, s36, 3008
    buffer_load_ushort v159, v8, s[12:15], s33 offen
    s_waitcnt vmcnt(0)
    v_lshl_or_b32 v216, v145, 16, v144
    v_lshl_or_b32 v217, v147, 16, v146
    v_lshl_or_b32 v218, v149, 16, v148
    v_lshl_or_b32 v219, v151, 16, v150
    v_lshl_or_b32 v220, v153, 16, v152
    v_lshl_or_b32 v221, v155, 16, v154
    v_lshl_or_b32 v222, v157, 16, v156
    v_lshl_or_b32 v223, v159, 16, v158
    s_add_u32 s33, s36, 4096
    buffer_load_ushort v144, v8, s[12:15], s33 offen
    s_add_u32 s33, s36, 4352
    buffer_load_ushort v145, v8, s[12:15], s33 offen
    s_add_u32 s33, s36, 4608
    buffer_load_ushort v146, v8, s[12:15], s33 offen
    s_add_u32 s33, s36, 4864
    buffer_load_ushort v147, v8, s[12:15], s33 offen
    s_add_u32 s33, s36, 6144
    buffer_load_ushort v148, v8, s[12:15], s33 offen
    s_add_u32 s33, s36, 6400
    buffer_load_ushort v149, v8, s[12:15], s33 offen
    s_add_u32 s33, s36, 6656
    buffer_load_ushort v150, v8, s[12:15], s33 offen
    s_add_u32 s33, s36, 6912
    buffer_load_ushort v151, v8, s[12:15], s33 offen
    s_add_u32 s33, s36, 4160
    buffer_load_ushort v152, v8, s[12:15], s33 offen
    s_add_u32 s33, s36, 4416
    buffer_load_ushort v153, v8, s[12:15], s33 offen
    s_add_u32 s33, s36, 4672
    buffer_load_ushort v154, v8, s[12:15], s33 offen
    s_add_u32 s33, s36, 4928
    buffer_load_ushort v155, v8, s[12:15], s33 offen
    s_add_u32 s33, s36, 6208
    buffer_load_ushort v156, v8, s[12:15], s33 offen
    s_add_u32 s33, s36, 6464
    buffer_load_ushort v157, v8, s[12:15], s33 offen
    s_add_u32 s33, s36, 6720
    buffer_load_ushort v158, v8, s[12:15], s33 offen
    s_add_u32 s33, s36, 6976
    buffer_load_ushort v159, v8, s[12:15], s33 offen
    s_waitcnt vmcnt(0)
    v_lshl_or_b32 v224, v145, 16, v144
    v_lshl_or_b32 v225, v147, 16, v146
    v_lshl_or_b32 v226, v149, 16, v148
    v_lshl_or_b32 v227, v151, 16, v150
    v_lshl_or_b32 v228, v153, 16, v152
    v_lshl_or_b32 v229, v155, 16, v154
    v_lshl_or_b32 v230, v157, 16, v156
    v_lshl_or_b32 v231, v159, 16, v158
    s_add_u32 s33, s36, 4224
    buffer_load_ushort v144, v8, s[12:15], s33 offen
    s_add_u32 s33, s36, 4480
    buffer_load_ushort v145, v8, s[12:15], s33 offen
    s_add_u32 s33, s36, 4736
    buffer_load_ushort v146, v8, s[12:15], s33 offen
    s_add_u32 s33, s36, 4992
    buffer_load_ushort v147, v8, s[12:15], s33 offen
    s_add_u32 s33, s36, 6272
    buffer_load_ushort v148, v8, s[12:15], s33 offen
    s_add_u32 s33, s36, 6528
    buffer_load_ushort v149, v8, s[12:15], s33 offen
    s_add_u32 s33, s36, 6784
    buffer_load_ushort v150, v8, s[12:15], s33 offen
    s_add_u32 s33, s36, 7040
    buffer_load_ushort v151, v8, s[12:15], s33 offen
    s_add_u32 s33, s36, 4288
    buffer_load_ushort v152, v8, s[12:15], s33 offen
    s_add_u32 s33, s36, 4544
    buffer_load_ushort v153, v8, s[12:15], s33 offen
    s_add_u32 s33, s36, 4800
    buffer_load_ushort v154, v8, s[12:15], s33 offen
    s_add_u32 s33, s36, 5056
    buffer_load_ushort v155, v8, s[12:15], s33 offen
    s_add_u32 s33, s36, 6336
    buffer_load_ushort v156, v8, s[12:15], s33 offen
    s_add_u32 s33, s36, 6592
    buffer_load_ushort v157, v8, s[12:15], s33 offen
    s_add_u32 s33, s36, 6848
    buffer_load_ushort v158, v8, s[12:15], s33 offen
    s_add_u32 s33, s36, 7104
    buffer_load_ushort v159, v8, s[12:15], s33 offen
    s_waitcnt vmcnt(0)
    v_lshl_or_b32 v232, v145, 16, v144
    v_lshl_or_b32 v233, v147, 16, v146
    v_lshl_or_b32 v234, v149, 16, v148
    v_lshl_or_b32 v235, v151, 16, v150
    v_lshl_or_b32 v236, v153, 16, v152
    v_lshl_or_b32 v237, v155, 16, v154
    v_lshl_or_b32 v238, v157, 16, v156
    v_lshl_or_b32 v239, v159, 16, v158
    s_waitcnt vmcnt(0)
    v_mfma_f32_32x32x16_bf16 v[128:143], v[176:179], v[32:35], 0
    v_mfma_f32_32x32x16_bf16 v[128:143], v[180:183], v[36:39], v[128:143]
    v_mfma_f32_32x32x16_bf16 v[128:143], v[184:187], v[40:43], v[128:143]
    v_mfma_f32_32x32x16_bf16 v[128:143], v[188:191], v[44:47], v[128:143]
    v_mfma_f32_32x32x16_bf16 v[128:143], v[192:195], v[48:51], v[128:143]
    v_mfma_f32_32x32x16_bf16 v[128:143], v[196:199], v[52:55], v[128:143]
    v_mfma_f32_32x32x16_bf16 v[128:143], v[200:203], v[56:59], v[128:143]
    v_mfma_f32_32x32x16_bf16 v[128:143], v[204:207], v[60:63], v[128:143]
    s_nop 11
    v_max3_f32 v9, v128, v129, v130
    v_max3_f32 v9, v9, v131, v132
    v_max3_f32 v9, v9, v133, v134
    v_max3_f32 v9, v9, v135, v136
    v_max3_f32 v9, v9, v137, v138
    v_max3_f32 v9, v9, v139, v140
    v_max3_f32 v9, v9, v141, v142
    v_max_f32 v9, v9, v143
    v_mov_b32 v10, v9
    s_nop 1
    v_permlane32_swap_b32 v9, v10
    v_max3_f32 v9, v9, v10, v5
    v_sub_f32 v6, v5, v9
    v_exp_f32 v6, v6
    v_mov_b32 v5, v9
    v_mul_f32 v2, v2, v6
    v_mul_f32 v64, v64, v6
    v_mul_f32 v65, v65, v6
    v_mul_f32 v66, v66, v6
    v_mul_f32 v67, v67, v6
    v_mul_f32 v68, v68, v6
    v_mul_f32 v69, v69, v6
    v_mul_f32 v70, v70, v6
    v_mul_f32 v71, v71, v6
    v_mul_f32 v72, v72, v6
    v_mul_f32 v73, v73, v6
    v_mul_f32 v74, v74, v6
    v_mul_f32 v75, v75, v6
    v_mul_f32 v76, v76, v6
    v_mul_f32 v77, v77, v6
    v_mul_f32 v78, v78, v6
    v_mul_f32 v79, v79, v6
    v_mul_f32 v80, v80, v6
    v_mul_f32 v81, v81, v6
    v_mul_f32 v82, v82, v6
    v_mul_f32 v83, v83, v6
    v_mul_f32 v84, v84, v6
    v_mul_f32 v85, v85, v6
    v_mul_f32 v86, v86, v6
    v_mul_f32 v87, v87, v6
    v_mul_f32 v88, v88, v6
    v_mul_f32 v89, v89, v6
    v_mul_f32 v90, v90, v6
    v_mul_f32 v91, v91, v6
    v_mul_f32 v92, v92, v6
    v_mul_f32 v93, v93, v6
    v_mul_f32 v94, v94, v6
    v_mul_f32 v95, v95, v6
    v_mul_f32 v96, v96, v6
    v_mul_f32 v97, v97, v6
    v_mul_f32 v98, v98, v6
    v_mul_f32 v99, v99, v6
    v_mul_f32 v100, v100, v6
    v_mul_f32 v101, v101, v6
    v_mul_f32 v102, v102, v6
    v_mul_f32 v103, v103, v6
    v_mul_f32 v104, v104, v6
    v_mul_f32 v105, v105, v6
    v_mul_f32 v106, v106, v6
    v_mul_f32 v107, v107, v6
    v_mul_f32 v108, v108, v6
    v_mul_f32 v109, v109, v6
    v_mul_f32 v110, v110, v6
    v_mul_f32 v111, v111, v6
    v_mul_f32 v112, v112, v6
    v_mul_f32 v113, v113, v6
    v_mul_f32 v114, v114, v6
    v_mul_f32 v115, v115, v6
    v_mul_f32 v116, v116, v6
    v_mul_f32 v117, v117, v6
    v_mul_f32 v118, v118, v6
    v_mul_f32 v119, v119, v6
    v_mul_f32 v120, v120, v6
    v_mul_f32 v121, v121, v6
    v_mul_f32 v122, v122, v6
    v_mul_f32 v123, v123, v6
    v_mul_f32 v124, v124, v6
    v_mul_f32 v125, v125, v6
    v_mul_f32 v126, v126, v6
    v_mul_f32 v127, v127, v6
    v_sub_f32 v128, v128, v5
    v_exp_f32 v128, v128
    v_sub_f32 v129, v129, v5
    v_exp_f32 v129, v129
    v_sub_f32 v130, v130, v5
    v_exp_f32 v130, v130
    v_sub_f32 v131, v131, v5
    v_exp_f32 v131, v131
    v_sub_f32 v132, v132, v5
    v_exp_f32 v132, v132
    v_sub_f32 v133, v133, v5
    v_exp_f32 v133, v133
    v_sub_f32 v134, v134, v5
    v_exp_f32 v134, v134
    v_sub_f32 v135, v135, v5
    v_exp_f32 v135, v135
    v_sub_f32 v136, v136, v5
    v_exp_f32 v136, v136
    v_sub_f32 v137, v137, v5
    v_exp_f32 v137, v137
    v_sub_f32 v138, v138, v5
    v_exp_f32 v138, v138
    v_sub_f32 v139, v139, v5
    v_exp_f32 v139, v139
    v_sub_f32 v140, v140, v5
    v_exp_f32 v140, v140
    v_sub_f32 v141, v141, v5
    v_exp_f32 v141, v141
    v_sub_f32 v142, v142, v5
    v_exp_f32 v142, v142
    v_sub_f32 v143, v143, v5
    v_exp_f32 v143, v143
    v_add_f32 v2, v2, v128
    v_add_f32 v2, v2, v129
    v_add_f32 v2, v2, v130
    v_add_f32 v2, v2, v131
    v_add_f32 v2, v2, v132
    v_add_f32 v2, v2, v133
    v_add_f32 v2, v2, v134
    v_add_f32 v2, v2, v135
    v_add_f32 v2, v2, v136
    v_add_f32 v2, v2, v137
    v_add_f32 v2, v2, v138
    v_add_f32 v2, v2, v139
    v_add_f32 v2, v2, v140
    v_add_f32 v2, v2, v141
    v_add_f32 v2, v2, v142
    v_add_f32 v2, v2, v143
    v_cvt_pk_bf16_f32 v160, v128, v129
    v_cvt_pk_bf16_f32 v161, v130, v131
    v_cvt_pk_bf16_f32 v162, v132, v133
    v_cvt_pk_bf16_f32 v163, v134, v135
    v_cvt_pk_bf16_f32 v164, v136, v137
    v_cvt_pk_bf16_f32 v165, v138, v139
    v_cvt_pk_bf16_f32 v166, v140, v141
    v_cvt_pk_bf16_f32 v167, v142, v143
    v_mfma_f32_32x32x16_bf16 v[64:79], v[208:211], v[160:163], v[64:79]
    v_mfma_f32_32x32x16_bf16 v[80:95], v[212:215], v[160:163], v[80:95]
    v_mfma_f32_32x32x16_bf16 v[96:111], v[216:219], v[160:163], v[96:111]
    v_mfma_f32_32x32x16_bf16 v[112:127], v[220:223], v[160:163], v[112:127]
    v_mfma_f32_32x32x16_bf16 v[64:79], v[224:227], v[164:167], v[64:79]
    v_mfma_f32_32x32x16_bf16 v[80:95], v[228:231], v[164:167], v[80:95]
    v_mfma_f32_32x32x16_bf16 v[96:111], v[232:235], v[164:167], v[96:111]
    v_mfma_f32_32x32x16_bf16 v[112:127], v[236:239], v[164:167], v[112:127]
    s_nop 15
    s_add_u32 s36, s36, 8192
    s_add_u32 s37, s37, 1
    s_cmp_lt_u32 s37, 32
    s_cbranch_scc1 standalone__mha_block_cached__near_ridge_kernel_Asl
    v_mov_b32 v4, v2
    s_nop 1
    v_permlane32_swap_b32 v2, v4
    v_add_f32 v2, v2, v4
    s_nop 1
    s_branch standalone__mha_block_cached__near_ridge_kernel_Anorm
standalone__mha_block_cached__near_ridge_kernel_done:
    s_endpgm
.section .rodata,"a"
.p2align 6
.amdhsa_kernel standalone__mha_block_cached__near_ridge_kernel
  .amdhsa_next_free_vgpr 256
  .amdhsa_next_free_sgpr 96
  .amdhsa_accum_offset 256
  .amdhsa_group_segment_fixed_size 0
  .amdhsa_kernarg_size 64
  .amdhsa_user_sgpr_count 2
  .amdhsa_user_sgpr_kernarg_segment_ptr 1
  .amdhsa_system_sgpr_workgroup_id_x 1
  .amdhsa_float_denorm_mode_32 3
  .amdhsa_float_denorm_mode_16_64 3
.end_amdhsa_kernel
```
